```python
import torch

def _softmax(x, axis=-1):
    return torch.softmax(x, dim=axis)
def _gelu(x):
    return torch.nn.functional.gelu(x, approximate="tanh")
def _silu(x):
    return torch.nn.functional.silu(x)
def _sigmoid(x):
    return torch.sigmoid(x)
def _layernorm(x, axis=-1, eps=1e-5):
    m = x.mean(dim=axis, keepdim=True)
    v = x.var(dim=axis, keepdim=True, unbiased=False)
    return (x - m) / torch.sqrt(v + eps)
def _scatter_add(tgt, idx, src, axis=0):
    return tgt.clone().index_add_(axis, idx, src)
def _segment_sum(src, seg, n):
    out = torch.zeros((n,) + src.shape[1:], dtype=src.dtype)
    return out.index_add_(0, seg, src)
def _pad(x, pw):
    flat = tuple(v for pair in reversed(pw) for v in pair)
    return torch.nn.functional.pad(x, flat)

kernel_name = 'parallel_sum__ssm_conv_h3__moe_arch_mod__prompt'

def setup_inputs():

    _w = (lambda a: (lambda t: t.to(torch.bfloat16) if t.is_floating_point() else t)(torch.as_tensor(a)))
    def _A_setup():
        B, S, D = 1, 2048, 576
        ks = 4
        return {
            "q": _w((lambda *s: torch.randn(*s, dtype=torch.bfloat16) * 0.05)(B, S, D)),
            "k": _w((lambda *s: torch.randn(*s, dtype=torch.bfloat16) * 0.8)(B, S, D)),
            "v": _w((lambda *s: torch.randn(*s, dtype=torch.bfloat16) * 0.8)(B, S, D)),
            "shift_k": _w((lambda *s: torch.randn(*s, dtype=torch.bfloat16) * 0.8)(D, ks) * 0.5),
            "ssm_k": _w((lambda *s: torch.randn(*s, dtype=torch.bfloat16) * 0.8)(D, S) * (1.0 / S ** 0.5)),
            "ssm_D": _w((lambda *s: torch.randn(*s, dtype=torch.bfloat16) * 0.8)(D)),
        }
    _A_in = _A_setup()

    def _B_setup():
        B, S, D, F, C = 1, 2048, 576, 4608, 8
        return {
            "x": _w((lambda *s: torch.randn(*s, dtype=torch.bfloat16) * 0.05)(B, S, D)),
            "w_r": _w((lambda *s: torch.randn(*s, dtype=torch.bfloat16) * 0.05)(D)),
            "w_gate": _w((lambda *s: torch.randn(*s, dtype=torch.bfloat16) * 0.05)(D, F)),
            "w_up": _w((lambda *s: torch.randn(*s, dtype=torch.bfloat16) * 0.05)(D, F)),
            "w_down": _w((lambda *s: torch.randn(*s, dtype=torch.bfloat16) * 0.05)(F, D)),
        }
    _B_in = _B_setup()

    return {
        "A_q": _A_in["q"],
        "A_k": _A_in["k"],
        "A_v": _A_in["v"],
        "A_shift_k": _A_in["shift_k"],
        "A_ssm_k": _A_in["ssm_k"],
        "A_ssm_D": _A_in["ssm_D"],
        "B_x": _B_in["x"],
        "B_w_r": _B_in["w_r"],
        "B_w_gate": _B_in["w_gate"],
        "B_w_up": _B_in["w_up"],
        "B_w_down": _B_in["w_down"],
    }

def reference(A_q, A_k, A_v, A_shift_k, A_ssm_k, A_ssm_D, B_x, B_w_r, B_w_gate, B_w_up, B_w_down):
    def _A_ref(q, k, v, shift_k, ssm_k, ssm_D):
        B, S, D = q.shape
        ks = shift_k.shape[-1]
        k_pad = _pad(k, ((0, 0), (ks - 1, 0), (0, 0)))
        k_shift = torch.zeros_like(k)
        for t in range(ks):
            k_shift = k_shift + k_pad[:, t:t + S, :] * shift_k[:, ks - 1 - t][None, None, :]
        kv = k_shift * v
        L = 2 * S
        kv_pad = _pad(kv, ((0, 0), (0, S), (0, 0)))
        kf_pad = _pad(ssm_k, ((0, 0), (0, S)))
        kv_f = (lambda x, axes=(-2,-1): torch.fft.rfft2(x.float(), dim=axes))(kv_pad[:, None, :, :], axes=(1, 2))
        kf_f = (lambda x, axes=(-2,-1): torch.fft.rfft2(x.float(), dim=axes))(kf_pad[:, None, :], axes=(1, 2))
        kf_f = (lambda x, *d: x.permute(*d))(kf_f, 1, 2, 0)
        y_f = kv_f * kf_f[None, :, :, :]
        y = (lambda x, s, axes=(-2,-1): torch.fft.irfft2(x, s=s, dim=axes).to(torch.bfloat16))(y_f, (1, L), axes=(1, 2))[:, 0, :S, :]
        y = y + kv * ssm_D[None, None, :]
        return q * y

    def _B_ref(x, w_r, w_gate, w_up, w_down):
        B, S, D = x.shape
        C = 8
        r = x @ w_r
        idx = torch.argsort(-r, axis=-1)[:, :C]
        idx_e = (lambda x, n, axis: torch.repeat_interleave(x, n, dim=axis))(idx.reshape(B, C, 1), D, axis=2)
        x_sel = (lambda x, i, axis: torch.take_along_dim(x, i, dim=axis))(x, idx_e, axis=1)
        g = _silu(x_sel @ w_gate)
        u = x_sel @ w_up
        y = (g * u) @ w_down
        r_sel = _sigmoid((lambda x, i, axis: torch.take_along_dim(x, i, dim=axis))(r, idx, axis=1))
        y = y * r_sel.reshape(B, C, 1)
        b_off = (torch.arange(B) * S).reshape(B, 1)
        flat_idx = (idx + b_off).reshape(B * C)
        zero = (x * 0.0).reshape(B * S, D)
        upd = _scatter_add(zero, flat_idx, y.reshape(B * C, D), axis=0)
        return x + upd.reshape(B, S, D)

    x = A_q
    xn = _layernorm(x, axis=-1)
    return x + _A_ref(xn, A_k, A_v, A_shift_k, A_ssm_k, A_ssm_D) + _B_ref(xn, B_w_r, B_w_gate, B_w_up, B_w_down)
```

```asm
; @launch grid=(256,1,1) block=(512,1,1) lds=163840
.amdgcn_target "amdgcn-amd-amdhsa--gfx950"
.text
.globl parallel_sum__ssm_conv_h3__moe_arch_mod__prompt_kernel
.p2align 8
.type parallel_sum__ssm_conv_h3__moe_arch_mod__prompt_kernel,@function
parallel_sum__ssm_conv_h3__moe_arch_mod__prompt_kernel:
  s_getpc_b64 s[96:97]
  s_cmp_ge_u32 s2, 256
  s_cbranch_scc1 L_done_1
  s_load_dwordx4 s[68:71], s[0:1], 96
  s_load_dwordx16 s[72:87], s[0:1], 0
  s_load_dwordx8 s[88:95], s[0:1], 64
  v_lshrrev_b32 v1, 6, v0
  s_and_b32 s30, s2, 7
  s_lshr_b32 s31, s2, 3
  v_readfirstlane_b32 s42, v1
  s_mov_b32 s40, 0xffff0000
  s_and_b32 s96, s96, 0xffffff00
  s_and_b32 s97, s97, 0xffff
  s_mov_b32 s98, L_code_end-parallel_sum__ssm_conv_h3__moe_arch_mod__prompt_kernel
  s_mov_b32 s99, 0x00020000
  v_and_b32 v243, 63, v0
  v_lshlrev_b32 v243, 4, v243
  s_lshl_b32 s3, s31, 10
  v_cmp_lt_u32 vcc, 447, v0
  s_cbranch_vccz L_noic_4
  buffer_load_dwordx4 v[244:247], v243, s[96:99], s3 offen
L_noic_4:
  s_waitcnt lgkmcnt(0)
  s_load_dword s46, s[70:71], 0
  s_mov_b32 s36, s70
  s_and_b32 s37, s71, 0xffff
  s_mov_b32 s38, 0x10000000
  s_mov_b32 s39, 0x00020000
  s_lshl_b32 s3, s2, 3
  s_add_u32 s3, s3, s42
  s_sub_u32 s41, s31, 5
  s_cmp_lt_u32 s41, 9
  s_cbranch_scc1 L_moe_2
  s_sub_u32 s41, s31, 0
  s_cmp_lt_u32 s41, 5
  s_cbranch_scc1 L_spare_3
  s_sub_u32 s31, s31, 14
  s_mul_i32 s41, s30, 18
  s_add_u32 s41, s41, s31
  s_and_b32 s43, s42, 3
  s_lshl_b32 s44, s41, 2
  s_add_u32 s44, s44, s43
  s_mul_i32 s45, s43, 37952
  s_lshr_b32 s60, s41, 4
  s_and_b32 s61, s41, 15
  v_mov_b32 v200, 0
  v_mov_b32 v201, 0
  s_cmp_ge_u32 s42, 4
  s_cbranch_scc1 L_ch_6
  s_setprio 2
  s_mov_b32 s48, s74
  s_and_b32 s49, s75, 0xffff
  s_mov_b32 s50, 0x240000
  s_mov_b32 s51, 0x00020000
  s_mov_b32 s52, s76
  s_and_b32 s53, s77, 0xffff
  s_mov_b32 s54, 0x240000
  s_mov_b32 s55, 0x00020000
  v_and_b32 v1, 63, v0
  v_lshrrev_b32 v4, 3, v1
  v_mul_u32_u24 v4, 1152, v4
  v_and_b32 v5, 7, v1
  v_lshl_add_u32 v4, v5, 4, v4
  s_mul_i32 s62, s61, 147456
  s_lshl_b32 s63, s60, 7
  s_add_u32 s62, s62, s63
  s_mul_i32 s63, s42, 9216
  s_add_u32 s62, s62, s63
  s_sub_u32 s63, s62, 9216
  s_lshl_b32 s64, s42, 10
  s_mov_b32 s16, s72
  s_and_b32 s17, s73, 0xffff
  s_mov_b32 s18, 0x240000
  s_mov_b32 s19, 0x00020000
  s_mov_b32 m0, s64
  s_add_u32 s65, s64, 17408
  buffer_load_dwordx4 v4, s[48:51], s63 offen nt lds
  s_mov_b32 m0, s65
  s_add_u32 s65, s64, 33792
  buffer_load_dwordx4 v4, s[52:55], s62 offen nt lds
  s_mov_b32 m0, s65
  s_add_u32 s64, s64, 4096
  buffer_load_dwordx4 v4, s[16:19], s62 offen nt lds
  s_add_u32 s63, s63, 36864
  s_add_u32 s62, s62, 36864
  s_mov_b32 m0, s64
  s_add_u32 s65, s64, 17408
  buffer_load_dwordx4 v4, s[48:51], s63 offen nt lds
  s_mov_b32 m0, s65
  s_add_u32 s65, s64, 33792
  buffer_load_dwordx4 v4, s[52:55], s62 offen nt lds
  s_mov_b32 m0, s65
  s_add_u32 s64, s64, 4096
  buffer_load_dwordx4 v4, s[16:19], s62 offen nt lds
  s_add_u32 s63, s63, 36864
  s_add_u32 s62, s62, 36864
  s_mov_b32 m0, s64
  s_add_u32 s65, s64, 17408
  buffer_load_dwordx4 v4, s[48:51], s63 offen nt lds
  s_mov_b32 m0, s65
  s_add_u32 s65, s64, 33792
  buffer_load_dwordx4 v4, s[52:55], s62 offen nt lds
  s_mov_b32 m0, s65
  s_add_u32 s64, s64, 4096
  buffer_load_dwordx4 v4, s[16:19], s62 offen nt lds
  s_add_u32 s63, s63, 36864
  s_add_u32 s62, s62, 36864
  s_mov_b32 m0, s64
  s_add_u32 s65, s64, 17408
  buffer_load_dwordx4 v4, s[48:51], s63 offen nt lds
  s_mov_b32 m0, s65
  s_add_u32 s65, s64, 33792
  buffer_load_dwordx4 v4, s[52:55], s62 offen nt lds
  s_mov_b32 m0, s65
  s_add_u32 s64, s64, 4096
  buffer_load_dwordx4 v4, s[16:19], s62 offen nt lds
  s_add_u32 s63, s63, 36864
  s_add_u32 s62, s62, 36864
  s_cmp_lg_u32 s42, 0
  s_cbranch_scc1 L_nok17_8
  s_mov_b32 m0, s64
  s_nop 0
  buffer_load_dwordx4 v4, s[48:51], s63 offen nt lds
L_nok17_8:
  s_mov_b32 s56, s78
  s_and_b32 s57, s79, 0xffff
  s_mov_b32 s58, 0x1200
  s_mov_b32 s59, 0x00020000
  v_and_b32 v2, 31, v0
  s_lshl_b32 s63, s60, 9
  v_lshl_add_u32 v29, v2, 4, s63
  buffer_load_dwordx4 v[32:35], v29, s[56:59], 0 offen
  v_lshrrev_b32 v3, 5, v0
  v_lshlrev_b32 v6, 10, v3
  v_lshl_add_u32 v6, v2, 2, v6
  v_mul_u32_u24 v7, 544, v2
  v_sub_u32 v8, 15, v3
  v_lshl_add_u32 v7, v8, 4, v7
  v_add_u32 v7, 50176, v7
  v_bfe_u32 v10, v0, 4, 2
  v_and_b32 v11, 15, v0
  v_mul_u32_u24 v8, 272, v10
  v_lshl_add_u32 v8, v11, 4, v8
  s_mul_i32 s63, s42, 2176
  s_add_u32 s63, s63, 50176
  v_add_u32 v8, s63, v8
  v_lshlrev_b32 v9, 12, v10
  v_lshl_add_u32 v9, v11, 4, v9
  s_lshl_b32 s63, s60, 6
  s_lshl_b32 s64, s42, 3
  s_add_u32 s63, s63, s64
  s_lshl_b32 s65, s63, 12
  s_lshl_b32 s64, s61, 8
  s_sub_u32 s65, s65, s64
  s_add_u32 s65, s65, 134912
  v_add_u32 v9, s65, v9
  v_lshlrev_b32 v12, 7, v10
  s_lshl_b32 s65, s63, 7
  s_lshl_b32 s64, s61, 3
  s_sub_u32 s65, s65, s64
  s_add_u32 s65, s65, 4194424
  v_add_u32 v12, s65, v12
  v_cmp_eq_u32 s[66:67], 0, v11
  v_mul_u32_u24 v13, 544, v2
  v_lshl_add_u32 v13, v3, 4, v13
  v_add_u32 v13, 67584, v13
  v_lshlrev_b32 v48, 12, v10
  v_lshl_add_u32 v48, v11, 4, v48
  s_lshl_b32 s65, s63, 12
  s_lshl_b32 s64, s61, 8
  s_add_u32 s65, s65, s64
  s_add_u32 s65, s65, 8388608
  v_add_u32 v48, s65, v48
  v_lshlrev_b32 v49, 7, v10
  s_lshl_b32 s65, s63, 7
  s_lshl_b32 s64, s61, 3
  s_add_u32 s65, s65, s64
  s_add_u32 s65, s65, 4718592
  v_add_u32 v49, s65, v49
  s_waitcnt lgkmcnt(0)
  s_mul_i32 s46, s46, 0x9E3779B1
  s_add_u32 s46, s46, 0x7F4A7C15
  v_mov_b32 v36, 0
  v_mov_b32 v37, 151808
  v_mov_b32 v38, 0
  v_mov_b32 v39, 0
  v_mov_b32 v40, 0
  v_mov_b32 v41, 0
  ds_write_b128 v37, v[38:41]
  ds_write_b128 v37, v[38:41] offset:16
  s_waitcnt lgkmcnt(0)
  s_branch L_cj_7
L_ch_6:
  s_mov_b32 s56, s78
  s_and_b32 s57, s79, 0xffff
  s_mov_b32 s58, 0x1200
  s_mov_b32 s59, 0x00020000
  v_and_b32 v2, 31, v0
  s_lshl_b32 s63, s60, 9
  v_lshl_add_u32 v29, v2, 4, s63
  buffer_load_dwordx4 v[32:35], v29, s[56:59], 0 offen
  v_lshrrev_b32 v3, 5, v0
  v_lshlrev_b32 v6, 10, v3
  v_lshl_add_u32 v6, v2, 2, v6
  v_mul_u32_u24 v7, 544, v2
  v_sub_u32 v8, 15, v3
  v_lshl_add_u32 v7, v8, 4, v7
  v_add_u32 v7, 50176, v7
  v_bfe_u32 v10, v0, 4, 2
  v_and_b32 v11, 15, v0
  v_mul_u32_u24 v8, 272, v10
  v_lshl_add_u32 v8, v11, 4, v8
  s_mul_i32 s63, s42, 2176
  s_add_u32 s63, s63, 50176
  v_add_u32 v8, s63, v8
  v_lshlrev_b32 v9, 12, v10
  v_lshl_add_u32 v9, v11, 4, v9
  s_lshl_b32 s63, s60, 6
  s_lshl_b32 s64, s42, 3
  s_add_u32 s63, s63, s64
  s_lshl_b32 s65, s63, 12
  s_lshl_b32 s64, s61, 8
  s_sub_u32 s65, s65, s64
  s_add_u32 s65, s65, 134912
  v_add_u32 v9, s65, v9
  v_lshlrev_b32 v12, 7, v10
  s_lshl_b32 s65, s63, 7
  s_lshl_b32 s64, s61, 3
  s_sub_u32 s65, s65, s64
  s_add_u32 s65, s65, 4194424
  v_add_u32 v12, s65, v12
  v_cmp_eq_u32 s[66:67], 0, v11
  v_mul_u32_u24 v13, 544, v2
  v_lshl_add_u32 v13, v3, 4, v13
  v_add_u32 v13, 67584, v13
  v_lshlrev_b32 v48, 12, v10
  v_lshl_add_u32 v48, v11, 4, v48
  s_lshl_b32 s65, s63, 12
  s_lshl_b32 s64, s61, 8
  s_add_u32 s65, s65, s64
  s_add_u32 s65, s65, 8388608
  v_add_u32 v48, s65, v48
  v_lshlrev_b32 v49, 7, v10
  s_lshl_b32 s65, s63, 7
  s_lshl_b32 s64, s61, 3
  s_add_u32 s65, s65, s64
  s_add_u32 s65, s65, 4718592
  v_add_u32 v49, s65, v49
  s_waitcnt lgkmcnt(0)
  s_mul_i32 s46, s46, 0x9E3779B1
  s_add_u32 s46, s46, 0x7F4A7C15
L_cj_7:
  s_waitcnt vmcnt(0)
  s_barrier
L_kvb_9:
  ds_read_b32 v14, v6 offset:640
  ds_read_b32 v15, v6 offset:768
  ds_read_b32 v16, v6 offset:896
  ds_read_b32 v17, v6 offset:1024
  ds_read_b32 v18, v6 offset:1152
  ds_read_b32 v19, v6 offset:1280
  ds_read_b32 v20, v6 offset:1408
  ds_read_b32 v21, v6 offset:1536
  ds_read_b32 v22, v6 offset:1664
  ds_read_b32 v23, v6 offset:1792
  ds_read_b32 v24, v6 offset:1920
  ds_read_b32 v40, v6 offset:17408
  ds_read_b32 v41, v6 offset:17536
  ds_read_b32 v42, v6 offset:17664
  ds_read_b32 v43, v6 offset:17792
  ds_read_b32 v44, v6 offset:17920
  ds_read_b32 v45, v6 offset:18048
  ds_read_b32 v46, v6 offset:18176
  ds_read_b32 v47, v6 offset:18304
  ds_read_b32 v144, v6 offset:33792
  ds_read_b32 v145, v6 offset:33920
  ds_read_b32 v146, v6 offset:34048
  ds_read_b32 v147, v6 offset:34176
  ds_read_b32 v148, v6 offset:34304
  ds_read_b32 v149, v6 offset:34432
  ds_read_b32 v150, v6 offset:34560
  ds_read_b32 v151, v6 offset:34688
  v_lshlrev_b32 v54, 16, v32
  v_lshlrev_b32 v55, 16, v34
  v_and_b32 v56, s40, v32
  v_and_b32 v57, s40, v34
  v_lshlrev_b32 v58, 16, v33
  v_lshlrev_b32 v59, 16, v35
  v_and_b32 v60, s40, v33
  v_and_b32 v61, s40, v35
  s_mov_b32 s64, 0x05040100
  s_mov_b32 s65, 0x07060302
  v_and_b32 v62, 0xffff, v32
  v_lshlrev_b32 v63, 16, v34
  v_lshrrev_b32 v64, 16, v32
  v_and_b32 v65, s40, v34
  v_and_b32 v66, 0xffff, v33
  v_lshlrev_b32 v67, 16, v35
  v_lshrrev_b32 v68, 16, v33
  v_and_b32 v69, s40, v35
  v_mov_b32 v70, 0x3f803f80
  v_mov_b32 v71, 0
  s_waitcnt lgkmcnt(0)
  v_perm_b32 v152, v145, v144, s64
  v_perm_b32 v156, v145, v144, s65
  v_perm_b32 v153, v147, v146, s64
  v_perm_b32 v157, v147, v146, s65
  v_perm_b32 v154, v149, v148, s64
  v_perm_b32 v158, v149, v148, s65
  v_perm_b32 v155, v151, v150, s64
  v_perm_b32 v159, v151, v150, s65
  ds_write_b128 v13, v[152:155]
  ds_write_b128 v13, v[156:159] offset:272
  v_dot2_f32_bf16 v72, v14, v68, 0
  v_dot2_f32_bf16 v76, v14, v69, 0
  v_dot2_f32_bf16 v80, v15, v68, 0
  v_dot2_f32_bf16 v84, v15, v69, 0
  v_dot2_f32_bf16 v88, v16, v68, 0
  v_dot2_f32_bf16 v92, v16, v69, 0
  v_dot2_f32_bf16 v96, v17, v68, 0
  v_dot2_f32_bf16 v132, v17, v69, 0
  v_dot2_f32_bf16 v73, v15, v66, 0
  v_dot2_f32_bf16 v77, v15, v67, 0
  v_dot2_f32_bf16 v81, v16, v66, 0
  v_dot2_f32_bf16 v85, v16, v67, 0
  v_dot2_f32_bf16 v89, v17, v66, 0
  v_dot2_f32_bf16 v93, v17, v67, 0
  v_dot2_f32_bf16 v97, v18, v66, 0
  v_dot2_f32_bf16 v133, v18, v67, 0
  v_dot2_f32_bf16 v75, v16, v64, 0
  v_dot2_f32_bf16 v79, v16, v65, 0
  v_dot2_f32_bf16 v83, v17, v64, 0
  v_dot2_f32_bf16 v87, v17, v65, 0
  v_dot2_f32_bf16 v91, v18, v64, 0
  v_dot2_f32_bf16 v95, v18, v65, 0
  v_dot2_f32_bf16 v99, v19, v64, 0
  v_dot2_f32_bf16 v135, v19, v65, 0
  v_cvt_pk_bf16_f32 v74, v72, v73
  v_cvt_pk_bf16_f32 v78, v76, v77
  v_cvt_pk_bf16_f32 v82, v80, v81
  v_cvt_pk_bf16_f32 v86, v84, v85
  v_cvt_pk_bf16_f32 v90, v88, v89
  v_cvt_pk_bf16_f32 v94, v92, v93
  v_cvt_pk_bf16_f32 v98, v96, v97
  v_cvt_pk_bf16_f32 v134, v132, v133
  v_dot2_f32_bf16 v73, v17, v62, 0
  v_dot2_f32_bf16 v77, v17, v63, 0
  v_dot2_f32_bf16 v81, v18, v62, 0
  v_dot2_f32_bf16 v85, v18, v63, 0
  v_dot2_f32_bf16 v89, v19, v62, 0
  v_dot2_f32_bf16 v93, v19, v63, 0
  v_dot2_f32_bf16 v97, v20, v62, 0
  v_dot2_f32_bf16 v133, v20, v63, 0
  v_dot2_f32_bf16 v72, v74, v70, 0
  v_dot2_f32_bf16 v76, v78, v70, 0
  v_dot2_f32_bf16 v80, v82, v70, 0
  v_dot2_f32_bf16 v84, v86, v70, 0
  v_dot2_f32_bf16 v88, v90, v70, 0
  v_dot2_f32_bf16 v92, v94, v70, 0
  v_dot2_f32_bf16 v96, v98, v70, 0
  v_dot2_f32_bf16 v132, v134, v70, 0
  v_cvt_pk_bf16_f32 v74, v72, v75
  v_cvt_pk_bf16_f32 v78, v76, v79
  v_cvt_pk_bf16_f32 v82, v80, v83
  v_cvt_pk_bf16_f32 v86, v84, v87
  v_cvt_pk_bf16_f32 v90, v88, v91
  v_cvt_pk_bf16_f32 v94, v92, v95
  v_cvt_pk_bf16_f32 v98, v96, v99
  v_cvt_pk_bf16_f32 v134, v132, v135
  v_dot2_f32_bf16 v72, v74, v70, 0
  v_dot2_f32_bf16 v76, v78, v70, 0
  v_dot2_f32_bf16 v80, v82, v70, 0
  v_dot2_f32_bf16 v84, v86, v70, 0
  v_dot2_f32_bf16 v88, v90, v70, 0
  v_dot2_f32_bf16 v92, v94, v70, 0
  v_dot2_f32_bf16 v96, v98, v70, 0
  v_dot2_f32_bf16 v132, v134, v70, 0
  v_cvt_pk_bf16_f32 v74, v72, v73
  v_cvt_pk_bf16_f32 v78, v76, v77
  v_cvt_pk_bf16_f32 v82, v80, v81
  v_cvt_pk_bf16_f32 v86, v84, v85
  v_cvt_pk_bf16_f32 v90, v88, v89
  v_cvt_pk_bf16_f32 v94, v92, v93
  v_cvt_pk_bf16_f32 v98, v96, v97
  v_cvt_pk_bf16_f32 v134, v132, v133
  v_dot2_f32_bf16 v72, v74, v70, 0
  v_dot2_f32_bf16 v76, v78, v70, 0
  v_dot2_f32_bf16 v80, v82, v70, 0
  v_dot2_f32_bf16 v84, v86, v70, 0
  v_dot2_f32_bf16 v88, v90, v70, 0
  v_dot2_f32_bf16 v92, v94, v70, 0
  v_dot2_f32_bf16 v96, v98, v70, 0
  v_dot2_f32_bf16 v132, v134, v70, 0
  v_cvt_pk_bf16_f32 v74, v72, v71
  v_cvt_pk_bf16_f32 v78, v71, v76
  v_cvt_pk_bf16_f32 v82, v80, v71
  v_cvt_pk_bf16_f32 v86, v71, v84
  v_cvt_pk_bf16_f32 v90, v88, v71
  v_cvt_pk_bf16_f32 v94, v71, v92
  v_cvt_pk_bf16_f32 v98, v96, v71
  v_cvt_pk_bf16_f32 v134, v71, v132
  v_dot2_f32_bf16 v100, v74, v40, 0
  v_dot2_f32_bf16 v101, v78, v40, 0
  v_dot2_f32_bf16 v102, v82, v41, 0
  v_dot2_f32_bf16 v103, v86, v41, 0
  v_dot2_f32_bf16 v104, v90, v42, 0
  v_dot2_f32_bf16 v105, v94, v42, 0
  v_dot2_f32_bf16 v106, v98, v43, 0
  v_dot2_f32_bf16 v107, v134, v43, 0
  v_dot2_f32_bf16 v72, v18, v68, 0
  v_dot2_f32_bf16 v76, v18, v69, 0
  v_dot2_f32_bf16 v80, v19, v68, 0
  v_dot2_f32_bf16 v84, v19, v69, 0
  v_dot2_f32_bf16 v88, v20, v68, 0
  v_dot2_f32_bf16 v92, v20, v69, 0
  v_dot2_f32_bf16 v96, v21, v68, 0
  v_dot2_f32_bf16 v132, v21, v69, 0
  v_dot2_f32_bf16 v73, v19, v66, 0
  v_dot2_f32_bf16 v77, v19, v67, 0
  v_dot2_f32_bf16 v81, v20, v66, 0
  v_dot2_f32_bf16 v85, v20, v67, 0
  v_dot2_f32_bf16 v89, v21, v66, 0
  v_dot2_f32_bf16 v93, v21, v67, 0
  v_dot2_f32_bf16 v97, v22, v66, 0
  v_dot2_f32_bf16 v133, v22, v67, 0
  v_dot2_f32_bf16 v75, v20, v64, 0
  v_dot2_f32_bf16 v79, v20, v65, 0
  v_dot2_f32_bf16 v83, v21, v64, 0
  v_dot2_f32_bf16 v87, v21, v65, 0
  v_dot2_f32_bf16 v91, v22, v64, 0
  v_dot2_f32_bf16 v95, v22, v65, 0
  v_dot2_f32_bf16 v99, v23, v64, 0
  v_dot2_f32_bf16 v135, v23, v65, 0
  v_cvt_pk_bf16_f32 v74, v72, v73
  v_cvt_pk_bf16_f32 v78, v76, v77
  v_cvt_pk_bf16_f32 v82, v80, v81
  v_cvt_pk_bf16_f32 v86, v84, v85
  v_cvt_pk_bf16_f32 v90, v88, v89
  v_cvt_pk_bf16_f32 v94, v92, v93
  v_cvt_pk_bf16_f32 v98, v96, v97
  v_cvt_pk_bf16_f32 v134, v132, v133
  v_dot2_f32_bf16 v73, v21, v62, 0
  v_dot2_f32_bf16 v77, v21, v63, 0
  v_dot2_f32_bf16 v81, v22, v62, 0
  v_dot2_f32_bf16 v85, v22, v63, 0
  v_dot2_f32_bf16 v89, v23, v62, 0
  v_dot2_f32_bf16 v93, v23, v63, 0
  v_dot2_f32_bf16 v97, v24, v62, 0
  v_dot2_f32_bf16 v133, v24, v63, 0
  v_dot2_f32_bf16 v72, v74, v70, 0
  v_dot2_f32_bf16 v76, v78, v70, 0
  v_dot2_f32_bf16 v80, v82, v70, 0
  v_dot2_f32_bf16 v84, v86, v70, 0
  v_dot2_f32_bf16 v88, v90, v70, 0
  v_dot2_f32_bf16 v92, v94, v70, 0
  v_dot2_f32_bf16 v96, v98, v70, 0
  v_dot2_f32_bf16 v132, v134, v70, 0
  v_cvt_pk_bf16_f32 v74, v72, v75
  v_cvt_pk_bf16_f32 v78, v76, v79
  v_cvt_pk_bf16_f32 v82, v80, v83
  v_cvt_pk_bf16_f32 v86, v84, v87
  v_cvt_pk_bf16_f32 v90, v88, v91
  v_cvt_pk_bf16_f32 v94, v92, v95
  v_cvt_pk_bf16_f32 v98, v96, v99
  v_cvt_pk_bf16_f32 v134, v132, v135
  v_dot2_f32_bf16 v72, v74, v70, 0
  v_dot2_f32_bf16 v76, v78, v70, 0
  v_dot2_f32_bf16 v80, v82, v70, 0
  v_dot2_f32_bf16 v84, v86, v70, 0
  v_dot2_f32_bf16 v88, v90, v70, 0
  v_dot2_f32_bf16 v92, v94, v70, 0
  v_dot2_f32_bf16 v96, v98, v70, 0
  v_dot2_f32_bf16 v132, v134, v70, 0
  v_cvt_pk_bf16_f32 v74, v72, v73
  v_cvt_pk_bf16_f32 v78, v76, v77
  v_cvt_pk_bf16_f32 v82, v80, v81
  v_cvt_pk_bf16_f32 v86, v84, v85
  v_cvt_pk_bf16_f32 v90, v88, v89
  v_cvt_pk_bf16_f32 v94, v92, v93
  v_cvt_pk_bf16_f32 v98, v96, v97
  v_cvt_pk_bf16_f32 v134, v132, v133
  v_dot2_f32_bf16 v72, v74, v70, 0
  v_dot2_f32_bf16 v76, v78, v70, 0
  v_dot2_f32_bf16 v80, v82, v70, 0
  v_dot2_f32_bf16 v84, v86, v70, 0
  v_dot2_f32_bf16 v88, v90, v70, 0
  v_dot2_f32_bf16 v92, v94, v70, 0
  v_dot2_f32_bf16 v96, v98, v70, 0
  v_dot2_f32_bf16 v132, v134, v70, 0
  v_cvt_pk_bf16_f32 v74, v72, v71
  v_cvt_pk_bf16_f32 v78, v71, v76
  v_cvt_pk_bf16_f32 v82, v80, v71
  v_cvt_pk_bf16_f32 v86, v71, v84
  v_cvt_pk_bf16_f32 v90, v88, v71
  v_cvt_pk_bf16_f32 v94, v71, v92
  v_cvt_pk_bf16_f32 v98, v96, v71
  v_cvt_pk_bf16_f32 v134, v71, v132
  v_dot2_f32_bf16 v108, v74, v44, 0
  v_dot2_f32_bf16 v109, v78, v44, 0
  v_dot2_f32_bf16 v110, v82, v45, 0
  v_dot2_f32_bf16 v111, v86, v45, 0
  v_dot2_f32_bf16 v112, v90, v46, 0
  v_dot2_f32_bf16 v113, v94, v46, 0
  v_dot2_f32_bf16 v114, v98, v47, 0
  v_dot2_f32_bf16 v115, v134, v47, 0
  s_nop 2
  v_cvt_pk_bf16_f32 v116, v114, v112
  v_cvt_pk_bf16_f32 v117, v110, v108
  v_cvt_pk_bf16_f32 v118, v106, v104
  v_cvt_pk_bf16_f32 v119, v102, v100
  v_cvt_pk_bf16_f32 v120, v115, v113
  v_cvt_pk_bf16_f32 v121, v111, v109
  v_cvt_pk_bf16_f32 v122, v107, v105
  v_cvt_pk_bf16_f32 v123, v103, v101
  ds_write_b128 v7, v[116:119]
  ds_write_b128 v7, v[120:123] offset:272
  s_waitcnt lgkmcnt(0)
  s_barrier
  ds_read_b128 v[116:119], v8
  ds_read_b128 v[120:123], v8 offset:1088
  s_movk_i32 s63, 16384
  s_waitcnt lgkmcnt(1)
  buffer_store_dwordx4 v[116:119], v9, s[36:39], 0 offen sc1
  v_xor_b32 v124, v116, v117
  v_xor_b32 v126, v118, v119
  s_waitcnt lgkmcnt(0)
  buffer_store_dwordx4 v[120:123], v9, s[36:39], s63 offen sc1
  v_xor_b32 v125, v120, v121
  v_xor_b32 v127, v122, v123
  v_xor_b32 v124, v124, v126
  v_xor_b32 v125, v125, v127
  s_nop 0
  v_xor_b32_dpp v124, v124, v124 quad_perm:[1,0,3,2] row_mask:0xf bank_mask:0xf
  v_xor_b32_dpp v125, v125, v125 quad_perm:[1,0,3,2] row_mask:0xf bank_mask:0xf
  s_nop 0
  v_xor_b32_dpp v124, v124, v124 quad_perm:[2,3,0,1] row_mask:0xf bank_mask:0xf
  v_xor_b32_dpp v125, v125, v125 quad_perm:[2,3,0,1] row_mask:0xf bank_mask:0xf
  s_nop 0
  v_xor_b32_dpp v124, v124, v124 row_half_mirror row_mask:0xf bank_mask:0xf
  v_xor_b32_dpp v125, v125, v125 row_half_mirror row_mask:0xf bank_mask:0xf
  s_nop 0
  v_xor_b32_dpp v124, v124, v124 row_mirror row_mask:0xf bank_mask:0xf
  v_xor_b32_dpp v125, v125, v125 row_mirror row_mask:0xf bank_mask:0xf
  v_xor_b32 v128, s46, v124
  v_xor_b32 v130, s46, v125
  v_mov_b32 v129, s46
  v_mov_b32 v131, s46
  s_mov_b64 exec, s[66:67]
  buffer_store_dwordx2 v[128:129], v12, s[36:39], 0 offen sc1
  buffer_store_dwordx2 v[130:131], v12, s[36:39], 0 offen offset:512 sc1
  s_mov_b64 exec, -1
  ds_read_b128 v[116:119], v8 offset:17408
  ds_read_b128 v[120:123], v8 offset:18496
  s_waitcnt lgkmcnt(1)
  buffer_store_dwordx4 v[116:119], v48, s[36:39], 0 offen sc1
  v_xor_b32 v124, v116, v117
  v_xor_b32 v126, v118, v119
  s_waitcnt lgkmcnt(0)
  buffer_store_dwordx4 v[120:123], v48, s[36:39], s63 offen sc1
  v_xor_b32 v125, v120, v121
  v_xor_b32 v127, v122, v123
  v_xor_b32 v124, v124, v126
  v_xor_b32 v125, v125, v127
  s_nop 0
  v_xor_b32_dpp v124, v124, v124 quad_perm:[1,0,3,2] row_mask:0xf bank_mask:0xf
  v_xor_b32_dpp v125, v125, v125 quad_perm:[1,0,3,2] row_mask:0xf bank_mask:0xf
  s_nop 0
  v_xor_b32_dpp v124, v124, v124 quad_perm:[2,3,0,1] row_mask:0xf bank_mask:0xf
  v_xor_b32_dpp v125, v125, v125 quad_perm:[2,3,0,1] row_mask:0xf bank_mask:0xf
  s_nop 0
  v_xor_b32_dpp v124, v124, v124 row_half_mirror row_mask:0xf bank_mask:0xf
  v_xor_b32_dpp v125, v125, v125 row_half_mirror row_mask:0xf bank_mask:0xf
  s_nop 0
  v_xor_b32_dpp v124, v124, v124 row_mirror row_mask:0xf bank_mask:0xf
  v_xor_b32_dpp v125, v125, v125 row_mirror row_mask:0xf bank_mask:0xf
  v_xor_b32 v128, s46, v124
  v_xor_b32 v130, s46, v125
  s_mov_b64 exec, s[66:67]
  buffer_store_dwordx2 v[128:129], v49, s[36:39], 0 offen sc1
  buffer_store_dwordx2 v[130:131], v49, s[36:39], 0 offen offset:512 sc1
  s_mov_b64 exec, -1
  s_cmp_lg_u32 s42, 0
  s_cbranch_scc1 L_noalive_12
  s_lshl_b32 s63, s41, 2
  s_add_u32 s63, s63, 4096
  v_mov_b32 v37, s46
  v_mov_b32 v36, 0
  s_mov_b64 exec, 1
  buffer_store_dword v37, v36, s[36:39], s63 offen sc1
  s_mov_b64 exec, -1
L_noalive_12:
  s_barrier
  s_cmp_lt_u32 s42, 4
  s_cbranch_scc1 L_cm_5
  s_mov_b32 s16, s72
  s_and_b32 s17, s73, 0xffff
  s_mov_b32 s18, 0x240000
  s_mov_b32 s19, 0x00020000
  v_and_b32 v201, 255, v0
  s_movk_i32 s63, 1152
  v_mul_lo_u32 v200, v201, s63
  s_lshl_b32 s63, s41, 3
  v_add_u32 v200, s63, v200
  s_mov_b32 s20, s94
  s_and_b32 s21, s95, 0xffff
  s_mov_b32 s22, 0x240000
  s_mov_b32 s23, 0x00020000
  v_and_b32 v1, 63, v0
  v_mov_b32 v5, v201
  v_mov_b32 v6, v200
  v_lshlrev_b32 v7, 3, v5
  s_setprio 1
  v_mov_b32 v64, 0
  v_mov_b32 v65, 0
  v_mov_b32 v66, 0
  v_mov_b32 v67, 0
  v_mov_b32 v68, 0
  v_mov_b32 v69, 0
  v_mov_b32 v70, 0
  v_mov_b32 v71, 0
  v_mov_b32 v72, 0
  v_mov_b32 v73, 0
  v_mov_b32 v74, 0
  v_mov_b32 v75, 0
  v_mov_b32 v76, 0
  v_mov_b32 v77, 0
  v_mov_b32 v78, 0
  v_mov_b32 v79, 0
  v_mov_b32 v80, 0
  v_mov_b32 v81, 0
  v_mov_b32 v82, 0
  v_mov_b32 v83, 0
  v_mov_b32 v84, 0
  v_mov_b32 v85, 0
  v_mov_b32 v86, 0
  v_mov_b32 v87, 0
  v_mov_b32 v88, 0
  v_mov_b32 v89, 0
  v_mov_b32 v90, 0
  v_mov_b32 v91, 0
  v_mov_b32 v92, 0
  v_mov_b32 v93, 0
  v_mov_b32 v94, 0
  v_mov_b32 v95, 0
  v_lshlrev_b32 v8, 4, v1
  v_lshrrev_b32 v9, 4, v1
  v_lshlrev_b32 v9, 3, v9
  s_lshl_b32 s48, s44, 12
  s_add_u32 s48, s48, 8388608
  s_lshl_b32 s50, s44, 7
  s_add_u32 s50, s50, 4718592
  s_sleep 32
  s_mov_b32 s51, 32768
  buffer_load_dwordx2 v[160:161], v7, s[36:39], s51 offen sc1
  s_mov_b32 s51, 34816
  buffer_load_dwordx2 v[162:163], v7, s[36:39], s51 offen sc1
  s_mov_b32 s51, 36864
  buffer_load_dwordx2 v[164:165], v7, s[36:39], s51 offen sc1
  s_mov_b32 s51, 38912
  buffer_load_dwordx2 v[166:167], v7, s[36:39], s51 offen sc1
  s_mov_b32 s51, 40960
  buffer_load_dwordx2 v[168:169], v7, s[36:39], s51 offen sc1
  s_mov_b32 s51, 43008
  buffer_load_dwordx2 v[170:171], v7, s[36:39], s51 offen sc1
  s_mov_b32 s51, 45056
  buffer_load_dwordx2 v[172:173], v7, s[36:39], s51 offen sc1
  s_mov_b32 s51, 47104
  buffer_load_dwordx2 v[174:175], v7, s[36:39], s51 offen sc1
  s_mov_b32 s52, 0
L_hp_13:
  buffer_load_dwordx4 v[224:227], v8, s[36:39], s48 offen offset:0 sc1
  buffer_load_dwordx4 v[228:231], v8, s[36:39], s48 offen offset:1024 sc1
  buffer_load_dwordx4 v[232:235], v8, s[36:39], s48 offen offset:2048 sc1
  buffer_load_dwordx4 v[236:239], v8, s[36:39], s48 offen offset:3072 sc1
  buffer_load_dword v240, v9, s[36:39], s50 offen offset:0 sc1
  buffer_load_dword v241, v9, s[36:39], s50 offen offset:32 sc1
  buffer_load_dword v242, v9, s[36:39], s50 offen offset:64 sc1
  buffer_load_dword v243, v9, s[36:39], s50 offen offset:96 sc1
  s_waitcnt vmcnt(0)
  v_xor_b32 v244, v224, v225
  v_xor_b32 v245, v228, v229
  v_xor_b32 v246, v232, v233
  v_xor_b32 v247, v236, v237
  v_xor_b32 v248, v226, v227
  v_xor_b32 v249, v230, v231
  v_xor_b32 v250, v234, v235
  v_xor_b32 v251, v238, v239
  v_xor_b32 v244, v244, v248
  v_xor_b32 v245, v245, v249
  v_xor_b32 v246, v246, v250
  v_xor_b32 v247, v247, v251
  v_xor_b32_dpp v244, v244, v244 quad_perm:[1,0,3,2] row_mask:0xf bank_mask:0xf
  v_xor_b32_dpp v245, v245, v245 quad_perm:[1,0,3,2] row_mask:0xf bank_mask:0xf
  v_xor_b32_dpp v246, v246, v246 quad_perm:[1,0,3,2] row_mask:0xf bank_mask:0xf
  v_xor_b32_dpp v247, v247, v247 quad_perm:[1,0,3,2] row_mask:0xf bank_mask:0xf
  v_xor_b32_dpp v244, v244, v244 quad_perm:[2,3,0,1] row_mask:0xf bank_mask:0xf
  v_xor_b32_dpp v245, v245, v245 quad_perm:[2,3,0,1] row_mask:0xf bank_mask:0xf
  v_xor_b32_dpp v246, v246, v246 quad_perm:[2,3,0,1] row_mask:0xf bank_mask:0xf
  v_xor_b32_dpp v247, v247, v247 quad_perm:[2,3,0,1] row_mask:0xf bank_mask:0xf
  v_xor_b32_dpp v244, v244, v244 row_half_mirror row_mask:0xf bank_mask:0xf
  v_xor_b32_dpp v245, v245, v245 row_half_mirror row_mask:0xf bank_mask:0xf
  v_xor_b32_dpp v246, v246, v246 row_half_mirror row_mask:0xf bank_mask:0xf
  v_xor_b32_dpp v247, v247, v247 row_half_mirror row_mask:0xf bank_mask:0xf
  v_xor_b32_dpp v244, v244, v244 row_mirror row_mask:0xf bank_mask:0xf
  v_xor_b32_dpp v245, v245, v245 row_mirror row_mask:0xf bank_mask:0xf
  v_xor_b32_dpp v246, v246, v246 row_mirror row_mask:0xf bank_mask:0xf
  v_xor_b32_dpp v247, v247, v247 row_mirror row_mask:0xf bank_mask:0xf
  v_xor_b32 v244, v244, v240
  v_xor_b32 v245, v245, v241
  v_xor_b32 v246, v246, v242
  v_xor_b32 v247, v247, v243
  v_cmp_eq_u32 vcc, s46, v244
  v_cmp_eq_u32 s[54:55], s46, v245
  s_and_b64 vcc, vcc, s[54:55]
  v_cmp_eq_u32 s[54:55], s46, v246
  s_and_b64 vcc, vcc, s[54:55]
  v_cmp_eq_u32 s[54:55], s46, v247
  s_and_b64 vcc, vcc, s[54:55]
  s_andn2_b64 exec, exec, vcc
  s_cbranch_scc0 L_hok_14
  s_add_u32 s52, s52, 1
  s_cmp_gt_u32 s52, 200000
  s_cbranch_scc1 L_hok_14
  s_sleep 8
  s_branch L_hp_13
L_hok_14:
  s_mov_b64 exec, -1
  v_mov_b32 v11, 151808
  v_mov_b32 v12, 1
  s_mov_b64 exec, 1
  ds_add_u32 v11, v12 offset:16
  s_mov_b64 exec, -1
  s_mov_b32 s52, 0
L_lw_15:
  ds_read_b32 v13, v11 offset:16
  s_add_u32 s52, s52, 1
  s_waitcnt lgkmcnt(0)
  s_cmp_gt_u32 s52, 1600000
  v_readfirstlane_b32 s51, v13
  s_cbranch_scc1 L_lwd_16
  s_nop 1
  s_cmp_ge_u32 s51, 4
  s_cbranch_scc1 L_lwd_16
  s_sleep 1
  s_branch L_lw_15
L_lwd_16:
  v_lshlrev_b32 v8, 1, v5
  s_lshl_b32 s48, s41, 14
  s_add_u32 s48, s48, 8388608
  buffer_load_short_d16_hi v64, v8, s[36:39], s48 offen offset:0 sc1
  buffer_load_short_d16_hi v68, v8, s[36:39], s48 offen offset:512 sc1
  buffer_load_short_d16_hi v72, v8, s[36:39], s48 offen offset:1024 sc1
  buffer_load_short_d16_hi v76, v8, s[36:39], s48 offen offset:1536 sc1
  buffer_load_short_d16_hi v80, v8, s[36:39], s48 offen offset:2048 sc1
  buffer_load_short_d16_hi v84, v8, s[36:39], s48 offen offset:2560 sc1
  buffer_load_short_d16_hi v88, v8, s[36:39], s48 offen offset:3072 sc1
  buffer_load_short_d16_hi v92, v8, s[36:39], s48 offen offset:3584 sc1
  s_add_u32 s48, s48, 4096
  buffer_load_short_d16_hi v65, v8, s[36:39], s48 offen offset:0 sc1
  buffer_load_short_d16_hi v69, v8, s[36:39], s48 offen offset:512 sc1
  buffer_load_short_d16_hi v73, v8, s[36:39], s48 offen offset:1024 sc1
  buffer_load_short_d16_hi v77, v8, s[36:39], s48 offen offset:1536 sc1
  buffer_load_short_d16_hi v81, v8, s[36:39], s48 offen offset:2048 sc1
  buffer_load_short_d16_hi v85, v8, s[36:39], s48 offen offset:2560 sc1
  buffer_load_short_d16_hi v89, v8, s[36:39], s48 offen offset:3072 sc1
  buffer_load_short_d16_hi v93, v8, s[36:39], s48 offen offset:3584 sc1
  s_add_u32 s48, s48, 4096
  buffer_load_short_d16_hi v66, v8, s[36:39], s48 offen offset:0 sc1
  buffer_load_short_d16_hi v70, v8, s[36:39], s48 offen offset:512 sc1
  buffer_load_short_d16_hi v74, v8, s[36:39], s48 offen offset:1024 sc1
  buffer_load_short_d16_hi v78, v8, s[36:39], s48 offen offset:1536 sc1
  buffer_load_short_d16_hi v82, v8, s[36:39], s48 offen offset:2048 sc1
  buffer_load_short_d16_hi v86, v8, s[36:39], s48 offen offset:2560 sc1
  buffer_load_short_d16_hi v90, v8, s[36:39], s48 offen offset:3072 sc1
  buffer_load_short_d16_hi v94, v8, s[36:39], s48 offen offset:3584 sc1
  s_add_u32 s48, s48, 4096
  buffer_load_short_d16_hi v67, v8, s[36:39], s48 offen offset:0 sc1
  buffer_load_short_d16_hi v71, v8, s[36:39], s48 offen offset:512 sc1
  buffer_load_short_d16_hi v75, v8, s[36:39], s48 offen offset:1024 sc1
  buffer_load_short_d16_hi v79, v8, s[36:39], s48 offen offset:1536 sc1
  buffer_load_short_d16_hi v83, v8, s[36:39], s48 offen offset:2048 sc1
  buffer_load_short_d16_hi v87, v8, s[36:39], s48 offen offset:2560 sc1
  buffer_load_short_d16_hi v91, v8, s[36:39], s48 offen offset:3072 sc1
  buffer_load_short_d16_hi v95, v8, s[36:39], s48 offen offset:3584 sc1
  s_add_u32 s48, s48, 4096
  s_mov_b32 s52, 0
  s_waitcnt vmcnt(32)
L_rowp_17:
  v_cmp_eq_u32 vcc, s46, v161
  v_cmp_eq_u32 s[54:55], s46, v163
  s_and_b64 vcc, vcc, s[54:55]
  v_cmp_eq_u32 s[54:55], s46, v165
  s_and_b64 vcc, vcc, s[54:55]
  v_cmp_eq_u32 s[54:55], s46, v167
  s_and_b64 vcc, vcc, s[54:55]
  v_cmp_eq_u32 s[54:55], s46, v169
  s_and_b64 vcc, vcc, s[54:55]
  v_cmp_eq_u32 s[54:55], s46, v171
  s_and_b64 vcc, vcc, s[54:55]
  v_cmp_eq_u32 s[54:55], s46, v173
  s_and_b64 vcc, vcc, s[54:55]
  v_cmp_eq_u32 s[54:55], s46, v175
  s_and_b64 vcc, vcc, s[54:55]
  s_andn2_b64 exec, exec, vcc
  s_cbranch_scc0 L_rowok_18
  s_add_u32 s52, s52, 1
  s_cmp_gt_u32 s52, 200000
  s_cbranch_scc1 L_rowok_18
  s_sleep 8
  s_mov_b32 s51, 32768
  buffer_load_dwordx2 v[160:161], v7, s[36:39], s51 offen sc1
  s_mov_b32 s51, 34816
  buffer_load_dwordx2 v[162:163], v7, s[36:39], s51 offen sc1
  s_mov_b32 s51, 36864
  buffer_load_dwordx2 v[164:165], v7, s[36:39], s51 offen sc1
  s_mov_b32 s51, 38912
  buffer_load_dwordx2 v[166:167], v7, s[36:39], s51 offen sc1
  s_mov_b32 s51, 40960
  buffer_load_dwordx2 v[168:169], v7, s[36:39], s51 offen sc1
  s_mov_b32 s51, 43008
  buffer_load_dwordx2 v[170:171], v7, s[36:39], s51 offen sc1
  s_mov_b32 s51, 45056
  buffer_load_dwordx2 v[172:173], v7, s[36:39], s51 offen sc1
  s_mov_b32 s51, 47104
  buffer_load_dwordx2 v[174:175], v7, s[36:39], s51 offen sc1
  s_waitcnt vmcnt(0)
  s_branch L_rowp_17
L_rowok_18:
  s_mov_b64 exec, -1
  v_and_b32 v176, s40, v160
  v_lshlrev_b32 v178, 16, v160
  v_and_b32 v180, s40, v162
  v_lshlrev_b32 v182, 16, v162
  v_and_b32 v184, s40, v164
  v_lshlrev_b32 v186, 16, v164
  v_and_b32 v188, s40, v166
  v_lshlrev_b32 v190, 16, v166
  v_and_b32 v192, s40, v168
  v_lshlrev_b32 v194, 16, v168
  v_and_b32 v196, s40, v170
  v_lshlrev_b32 v198, 16, v170
  v_and_b32 v200, s40, v172
  v_lshlrev_b32 v202, 16, v172
  v_and_b32 v204, s40, v174
  v_lshlrev_b32 v206, 16, v174
  v_rcp_f32 v176, v176
  v_rcp_f32 v180, v180
  v_rcp_f32 v184, v184
  v_rcp_f32 v188, v188
  v_rcp_f32 v192, v192
  v_rcp_f32 v196, v196
  v_rcp_f32 v200, v200
  v_rcp_f32 v204, v204
  v_mul_f32_e64 v178, -v178, v176
  v_mov_b32 v177, v176
  v_mul_f32_e64 v182, -v182, v180
  v_mov_b32 v181, v180
  v_mul_f32_e64 v186, -v186, v184
  v_mov_b32 v185, v184
  v_mul_f32_e64 v190, -v190, v188
  v_mov_b32 v189, v188
  v_mul_f32_e64 v194, -v194, v192
  v_mov_b32 v193, v192
  v_mul_f32_e64 v198, -v198, v196
  v_mov_b32 v197, v196
  v_mul_f32_e64 v202, -v202, v200
  v_mov_b32 v201, v200
  v_mul_f32_e64 v206, -v206, v204
  v_mov_b32 v205, v204
  v_mov_b32 v179, v178
  v_mov_b32 v183, v182
  v_mov_b32 v187, v186
  v_mov_b32 v191, v190
  v_mov_b32 v195, v194
  v_mov_b32 v199, v198
  v_mov_b32 v203, v202
  v_mov_b32 v207, v206
  s_waitcnt vmcnt(0)
  v_pk_fma_f32 v[96:97], v[64:65], v[176:177], v[178:179]
  v_pk_fma_f32 v[98:99], v[66:67], v[176:177], v[178:179]
  v_pk_fma_f32 v[100:101], v[68:69], v[180:181], v[182:183]
  v_pk_fma_f32 v[102:103], v[70:71], v[180:181], v[182:183]
  v_pk_fma_f32 v[104:105], v[72:73], v[184:185], v[186:187]
  v_pk_fma_f32 v[106:107], v[74:75], v[184:185], v[186:187]
  v_pk_fma_f32 v[108:109], v[76:77], v[188:189], v[190:191]
  v_pk_fma_f32 v[110:111], v[78:79], v[188:189], v[190:191]
  v_pk_fma_f32 v[112:113], v[80:81], v[192:193], v[194:195]
  v_pk_fma_f32 v[114:115], v[82:83], v[192:193], v[194:195]
  v_pk_fma_f32 v[116:117], v[84:85], v[196:197], v[198:199]
  v_pk_fma_f32 v[118:119], v[86:87], v[196:197], v[198:199]
  v_pk_fma_f32 v[120:121], v[88:89], v[200:201], v[202:203]
  v_pk_fma_f32 v[122:123], v[90:91], v[200:201], v[202:203]
  v_pk_fma_f32 v[124:125], v[92:93], v[204:205], v[206:207]
  v_pk_fma_f32 v[126:127], v[94:95], v[204:205], v[206:207]
  v_lshlrev_b32 v9, 1, v5
  v_add_u32 v9, 33296, v9
  v_add_u32 v10, 75904, v9
  v_mov_b32 v11, 151808
  v_mov_b32 v40, 0
  v_mov_b32 v41, 0
  v_mov_b32 v42, 0
  v_mov_b32 v43, 0
  v_and_b32 v8, 7, v1
  v_lshlrev_b32 v8, 3, v8
  s_mov_b32 s52, 0
L_selp_19:
  s_movk_i32 s51, 256
  buffer_load_dwordx2 v[180:181], v8, s[36:39], s51 offen sc1
  s_waitcnt vmcnt(0)
  v_cmp_eq_u32 vcc, s46, v181
  s_andn2_b64 exec, exec, vcc
  s_cbranch_scc0 L_selok_20
  s_add_u32 s52, s52, 1
  s_cmp_gt_u32 s52, 200000
  s_cbranch_scc1 L_selok_20
  s_sleep 4
  s_branch L_selp_19
L_selok_20:
  s_mov_b64 exec, -1
  v_lshrrev_b32 v183, 16, v180
  v_and_b32 v46, 0x8000, v183
  v_mov_b32 v47, 0xffff
  v_mov_b32 v48, 0x8000
  v_cmp_ne_u32 vcc, 0, v46
  v_and_b32 v182, 0xffff, v180
  v_sub_u32 v182, 2047, v182
  v_cndmask_b32 v47, v47, v48, vcc
  v_xor_b32 v183, v183, v47
  v_lshlrev_b32 v183, 16, v183
  v_mul_f32 v183, 0xbfb8aa3b, v183
  v_exp_f32 v183, v183
  s_nop 0
  v_add_f32 v183, 1.0, v183
  v_rcp_f32 v183, v183
  s_nop 0
  v_cvt_pk_bf16_f32 v183, v183, v183
  v_lshlrev_b32 v183, 16, v183
  v_mov_b32 v184, 0
  v_readlane_b32 s51, v182, 0
  s_nop 3
  s_lshr_b32 s58, s51, 8
  s_lshl_b32 s58, 1, s58
  s_and_b32 s51, s51, 255
  v_mov_b32 v185, s58
  v_cmp_eq_u32 vcc, s51, v5
  s_nop 1
  v_cndmask_b32 v185, 0, v185, vcc
  v_or_b32 v184, v184, v185
  v_readlane_b32 s51, v182, 1
  s_nop 3
  s_lshr_b32 s58, s51, 8
  s_lshl_b32 s58, 1, s58
  s_and_b32 s51, s51, 255
  v_mov_b32 v185, s58
  v_cmp_eq_u32 vcc, s51, v5
  s_nop 1
  v_cndmask_b32 v185, 0, v185, vcc
  v_or_b32 v184, v184, v185
  v_readlane_b32 s51, v182, 2
  s_nop 3
  s_lshr_b32 s58, s51, 8
  s_lshl_b32 s58, 1, s58
  s_and_b32 s51, s51, 255
  v_mov_b32 v185, s58
  v_cmp_eq_u32 vcc, s51, v5
  s_nop 1
  v_cndmask_b32 v185, 0, v185, vcc
  v_or_b32 v184, v184, v185
  v_readlane_b32 s51, v182, 3
  s_nop 3
  s_lshr_b32 s58, s51, 8
  s_lshl_b32 s58, 1, s58
  s_and_b32 s51, s51, 255
  v_mov_b32 v185, s58
  v_cmp_eq_u32 vcc, s51, v5
  s_nop 1
  v_cndmask_b32 v185, 0, v185, vcc
  v_or_b32 v184, v184, v185
  v_readlane_b32 s51, v182, 4
  s_nop 3
  s_lshr_b32 s58, s51, 8
  s_lshl_b32 s58, 1, s58
  s_and_b32 s51, s51, 255
  v_mov_b32 v185, s58
  v_cmp_eq_u32 vcc, s51, v5
  s_nop 1
  v_cndmask_b32 v185, 0, v185, vcc
  v_or_b32 v184, v184, v185
  v_readlane_b32 s51, v182, 5
  s_nop 3
  s_lshr_b32 s58, s51, 8
  s_lshl_b32 s58, 1, s58
  s_and_b32 s51, s51, 255
  v_mov_b32 v185, s58
  v_cmp_eq_u32 vcc, s51, v5
  s_nop 1
  v_cndmask_b32 v185, 0, v185, vcc
  v_or_b32 v184, v184, v185
  v_readlane_b32 s51, v182, 6
  s_nop 3
  s_lshr_b32 s58, s51, 8
  s_lshl_b32 s58, 1, s58
  s_and_b32 s51, s51, 255
  v_mov_b32 v185, s58
  v_cmp_eq_u32 vcc, s51, v5
  s_nop 1
  v_cndmask_b32 v185, 0, v185, vcc
  v_or_b32 v184, v184, v185
  v_readlane_b32 s51, v182, 7
  s_nop 3
  s_lshr_b32 s58, s51, 8
  s_lshl_b32 s58, 1, s58
  s_and_b32 s51, s51, 255
  v_mov_b32 v185, s58
  v_cmp_eq_u32 vcc, s51, v5
  s_nop 1
  v_cndmask_b32 v185, 0, v185, vcc
  v_or_b32 v184, v184, v185
  s_mov_b32 s59, 0
  s_setprio 1
  s_cmp_gt_u32 s59, 0
  s_cbranch_scc1 L_yg_22
  s_mov_b32 s52, 0
L_yw_21:
  ds_read_b128 v[16:19], v11
  s_add_u32 s52, s52, 1
  s_waitcnt lgkmcnt(0)
  v_min_u32 v16, v16, v17
  v_min3_u32 v16, v16, v18, v19
  s_cmp_gt_u32 s52, 200000
  v_readfirstlane_b32 s59, v16
  s_cbranch_scc1 L_yg_22
  s_nop 1
  s_cmp_gt_u32 s59, 0
  s_cbranch_scc1 L_yg_22
  s_sleep 1
  s_branch L_yw_21
L_yg_22:
  ds_read_u16_d16_hi v40, v9 offset:0
  ds_read_u16_d16_hi v41, v9 offset:37952
  ds_read_u16_d16_hi v42, v10 offset:0
  ds_read_u16_d16_hi v43, v10 offset:37952
  s_waitcnt lgkmcnt(0)
  v_pk_fma_f32 v[128:129], v[96:97], v[40:41], v[96:97]
  v_pk_fma_f32 v[130:131], v[98:99], v[42:43], v[98:99]
  v_pk_add_f32 v[128:129], v[128:129], v[64:65]
  v_pk_add_f32 v[130:131], v[130:131], v[66:67]
  v_cvt_pk_bf16_f32 v44, v128, v129
  v_cvt_pk_bf16_f32 v45, v130, v131
  v_and_b32 v48, 1, v184
  s_mov_b32 s51, 0
  v_cmp_eq_u32 vcc, 0, v48
  s_mov_b64 exec, vcc
  buffer_store_dwordx2 v[44:45], v6, s[20:23], s51 offen
  s_mov_b64 exec, -1
  s_cmp_gt_u32 s59, 1
  s_cbranch_scc1 L_yg_24
  s_mov_b32 s52, 0
L_yw_23:
  ds_read_b128 v[16:19], v11
  s_add_u32 s52, s52, 1
  s_waitcnt lgkmcnt(0)
  v_min_u32 v16, v16, v17
  v_min3_u32 v16, v16, v18, v19
  s_cmp_gt_u32 s52, 200000
  v_readfirstlane_b32 s59, v16
  s_cbranch_scc1 L_yg_24
  s_nop 1
  s_cmp_gt_u32 s59, 1
  s_cbranch_scc1 L_yg_24
  s_sleep 1
  s_branch L_yw_23
L_yg_24:
  ds_read_u16_d16_hi v40, v9 offset:512
  ds_read_u16_d16_hi v41, v9 offset:38464
  ds_read_u16_d16_hi v42, v10 offset:512
  ds_read_u16_d16_hi v43, v10 offset:38464
  s_waitcnt lgkmcnt(0)
  v_pk_fma_f32 v[132:133], v[100:101], v[40:41], v[100:101]
  v_pk_fma_f32 v[134:135], v[102:103], v[42:43], v[102:103]
  v_pk_add_f32 v[132:133], v[132:133], v[68:69]
  v_pk_add_f32 v[134:135], v[134:135], v[70:71]
  v_cvt_pk_bf16_f32 v46, v132, v133
  v_cvt_pk_bf16_f32 v47, v134, v135
  v_and_b32 v48, 2, v184
  s_mov_b32 s51, 294912
  v_cmp_eq_u32 vcc, 0, v48
  s_mov_b64 exec, vcc
  buffer_store_dwordx2 v[46:47], v6, s[20:23], s51 offen
  s_mov_b64 exec, -1
  s_cmp_gt_u32 s59, 2
  s_cbranch_scc1 L_yg_26
  s_mov_b32 s52, 0
L_yw_25:
  ds_read_b128 v[16:19], v11
  s_add_u32 s52, s52, 1
  s_waitcnt lgkmcnt(0)
  v_min_u32 v16, v16, v17
  v_min3_u32 v16, v16, v18, v19
  s_cmp_gt_u32 s52, 200000
  v_readfirstlane_b32 s59, v16
  s_cbranch_scc1 L_yg_26
  s_nop 1
  s_cmp_gt_u32 s59, 2
  s_cbranch_scc1 L_yg_26
  s_sleep 1
  s_branch L_yw_25
L_yg_26:
  ds_read_u16_d16_hi v40, v9 offset:1024
  ds_read_u16_d16_hi v41, v9 offset:38976
  ds_read_u16_d16_hi v42, v10 offset:1024
  ds_read_u16_d16_hi v43, v10 offset:38976
  s_waitcnt lgkmcnt(0)
  v_pk_fma_f32 v[136:137], v[104:105], v[40:41], v[104:105]
  v_pk_fma_f32 v[138:139], v[106:107], v[42:43], v[106:107]
  v_pk_add_f32 v[136:137], v[136:137], v[72:73]
  v_pk_add_f32 v[138:139], v[138:139], v[74:75]
  v_cvt_pk_bf16_f32 v44, v136, v137
  v_cvt_pk_bf16_f32 v45, v138, v139
  v_and_b32 v48, 4, v184
  s_mov_b32 s51, 589824
  v_cmp_eq_u32 vcc, 0, v48
  s_mov_b64 exec, vcc
  buffer_store_dwordx2 v[44:45], v6, s[20:23], s51 offen
  s_mov_b64 exec, -1
  s_cmp_gt_u32 s59, 3
  s_cbranch_scc1 L_yg_28
  s_mov_b32 s52, 0
L_yw_27:
  ds_read_b128 v[16:19], v11
  s_add_u32 s52, s52, 1
  s_waitcnt lgkmcnt(0)
  v_min_u32 v16, v16, v17
  v_min3_u32 v16, v16, v18, v19
  s_cmp_gt_u32 s52, 200000
  v_readfirstlane_b32 s59, v16
  s_cbranch_scc1 L_yg_28
  s_nop 1
  s_cmp_gt_u32 s59, 3
  s_cbranch_scc1 L_yg_28
  s_sleep 1
  s_branch L_yw_27
L_yg_28:
  ds_read_u16_d16_hi v40, v9 offset:1536
  ds_read_u16_d16_hi v41, v9 offset:39488
  ds_read_u16_d16_hi v42, v10 offset:1536
  ds_read_u16_d16_hi v43, v10 offset:39488
  s_waitcnt lgkmcnt(0)
  v_pk_fma_f32 v[140:141], v[108:109], v[40:41], v[108:109]
  v_pk_fma_f32 v[142:143], v[110:111], v[42:43], v[110:111]
  v_pk_add_f32 v[140:141], v[140:141], v[76:77]
  v_pk_add_f32 v[142:143], v[142:143], v[78:79]
  v_cvt_pk_bf16_f32 v46, v140, v141
  v_cvt_pk_bf16_f32 v47, v142, v143
  v_and_b32 v48, 8, v184
  s_mov_b32 s51, 884736
  v_cmp_eq_u32 vcc, 0, v48
  s_mov_b64 exec, vcc
  buffer_store_dwordx2 v[46:47], v6, s[20:23], s51 offen
  s_mov_b64 exec, -1
  s_cmp_gt_u32 s59, 4
  s_cbranch_scc1 L_yg_30
  s_mov_b32 s52, 0
L_yw_29:
  ds_read_b128 v[16:19], v11
  s_add_u32 s52, s52, 1
  s_waitcnt lgkmcnt(0)
  v_min_u32 v16, v16, v17
  v_min3_u32 v16, v16, v18, v19
  s_cmp_gt_u32 s52, 200000
  v_readfirstlane_b32 s59, v16
  s_cbranch_scc1 L_yg_30
  s_nop 1
  s_cmp_gt_u32 s59, 4
  s_cbranch_scc1 L_yg_30
  s_sleep 1
  s_branch L_yw_29
L_yg_30:
  ds_read_u16_d16_hi v40, v9 offset:2048
  ds_read_u16_d16_hi v41, v9 offset:40000
  ds_read_u16_d16_hi v42, v10 offset:2048
  ds_read_u16_d16_hi v43, v10 offset:40000
  s_waitcnt lgkmcnt(0)
  v_pk_fma_f32 v[144:145], v[112:113], v[40:41], v[112:113]
  v_pk_fma_f32 v[146:147], v[114:115], v[42:43], v[114:115]
  v_pk_add_f32 v[144:145], v[144:145], v[80:81]
  v_pk_add_f32 v[146:147], v[146:147], v[82:83]
  v_cvt_pk_bf16_f32 v44, v144, v145
  v_cvt_pk_bf16_f32 v45, v146, v147
  v_and_b32 v48, 16, v184
  s_mov_b32 s51, 1179648
  v_cmp_eq_u32 vcc, 0, v48
  s_mov_b64 exec, vcc
  buffer_store_dwordx2 v[44:45], v6, s[20:23], s51 offen
  s_mov_b64 exec, -1
  s_cmp_gt_u32 s59, 5
  s_cbranch_scc1 L_yg_32
  s_mov_b32 s52, 0
L_yw_31:
  ds_read_b128 v[16:19], v11
  s_add_u32 s52, s52, 1
  s_waitcnt lgkmcnt(0)
  v_min_u32 v16, v16, v17
  v_min3_u32 v16, v16, v18, v19
  s_cmp_gt_u32 s52, 200000
  v_readfirstlane_b32 s59, v16
  s_cbranch_scc1 L_yg_32
  s_nop 1
  s_cmp_gt_u32 s59, 5
  s_cbranch_scc1 L_yg_32
  s_sleep 1
  s_branch L_yw_31
L_yg_32:
  ds_read_u16_d16_hi v40, v9 offset:2560
  ds_read_u16_d16_hi v41, v9 offset:40512
  ds_read_u16_d16_hi v42, v10 offset:2560
  ds_read_u16_d16_hi v43, v10 offset:40512
  s_waitcnt lgkmcnt(0)
  v_pk_fma_f32 v[148:149], v[116:117], v[40:41], v[116:117]
  v_pk_fma_f32 v[150:151], v[118:119], v[42:43], v[118:119]
  v_pk_add_f32 v[148:149], v[148:149], v[84:85]
  v_pk_add_f32 v[150:151], v[150:151], v[86:87]
  v_cvt_pk_bf16_f32 v46, v148, v149
  v_cvt_pk_bf16_f32 v47, v150, v151
  v_and_b32 v48, 32, v184
  s_mov_b32 s51, 1474560
  v_cmp_eq_u32 vcc, 0, v48
  s_mov_b64 exec, vcc
  buffer_store_dwordx2 v[46:47], v6, s[20:23], s51 offen
  s_mov_b64 exec, -1
  s_cmp_gt_u32 s59, 6
  s_cbranch_scc1 L_yg_34
  s_mov_b32 s52, 0
L_yw_33:
  ds_read_b128 v[16:19], v11
  s_add_u32 s52, s52, 1
  s_waitcnt lgkmcnt(0)
  v_min_u32 v16, v16, v17
  v_min3_u32 v16, v16, v18, v19
  s_cmp_gt_u32 s52, 200000
  v_readfirstlane_b32 s59, v16
  s_cbranch_scc1 L_yg_34
  s_nop 1
  s_cmp_gt_u32 s59, 6
  s_cbranch_scc1 L_yg_34
  s_sleep 1
  s_branch L_yw_33
L_yg_34:
  ds_read_u16_d16_hi v40, v9 offset:3072
  ds_read_u16_d16_hi v41, v9 offset:41024
  ds_read_u16_d16_hi v42, v10 offset:3072
  ds_read_u16_d16_hi v43, v10 offset:41024
  s_waitcnt lgkmcnt(0)
  v_pk_fma_f32 v[152:153], v[120:121], v[40:41], v[120:121]
  v_pk_fma_f32 v[154:155], v[122:123], v[42:43], v[122:123]
  v_pk_add_f32 v[152:153], v[152:153], v[88:89]
  v_pk_add_f32 v[154:155], v[154:155], v[90:91]
  v_cvt_pk_bf16_f32 v44, v152, v153
  v_cvt_pk_bf16_f32 v45, v154, v155
  v_and_b32 v48, 64, v184
  s_mov_b32 s51, 1769472
  v_cmp_eq_u32 vcc, 0, v48
  s_mov_b64 exec, vcc
  buffer_store_dwordx2 v[44:45], v6, s[20:23], s51 offen
  s_mov_b64 exec, -1
  s_cmp_gt_u32 s59, 7
  s_cbranch_scc1 L_yg_36
  s_mov_b32 s52, 0
L_yw_35:
  ds_read_b128 v[16:19], v11
  s_add_u32 s52, s52, 1
  s_waitcnt lgkmcnt(0)
  v_min_u32 v16, v16, v17
  v_min3_u32 v16, v16, v18, v19
  s_cmp_gt_u32 s52, 200000
  v_readfirstlane_b32 s59, v16
  s_cbranch_scc1 L_yg_36
  s_nop 1
  s_cmp_gt_u32 s59, 7
  s_cbranch_scc1 L_yg_36
  s_sleep 1
  s_branch L_yw_35
L_yg_36:
  ds_read_u16_d16_hi v40, v9 offset:3584
  ds_read_u16_d16_hi v41, v9 offset:41536
  ds_read_u16_d16_hi v42, v10 offset:3584
  ds_read_u16_d16_hi v43, v10 offset:41536
  s_waitcnt lgkmcnt(0)
  v_pk_fma_f32 v[156:157], v[124:125], v[40:41], v[124:125]
  v_pk_fma_f32 v[158:159], v[126:127], v[42:43], v[126:127]
  v_pk_add_f32 v[156:157], v[156:157], v[92:93]
  v_pk_add_f32 v[158:159], v[158:159], v[94:95]
  v_cvt_pk_bf16_f32 v46, v156, v157
  v_cvt_pk_bf16_f32 v47, v158, v159
  v_and_b32 v48, 128, v184
  s_mov_b32 s51, 2064384
  v_cmp_eq_u32 vcc, 0, v48
  s_mov_b64 exec, vcc
  buffer_store_dwordx2 v[46:47], v6, s[20:23], s51 offen
  s_mov_b64 exec, -1
  v_readlane_b32 s51, v182, 0
  v_mov_b32 v52, 151872
  s_nop 2
  s_bfe_u32 s58, s51, 0x20006
  s_cmp_lg_u32 s58, s43
  s_cbranch_scc1 L_ns_37
  s_lshr_b32 s58, s51, 8
  s_lshl_b32 s58, s58, 2
  s_and_b32 s51, s51, 255
  v_cmp_eq_u32 vcc, s51, v5
  s_set_gpr_idx_on s58, gpr_idx(SRC0)
  v_mov_b32 v36, v128
  v_mov_b32 v37, v129
  v_mov_b32 v38, v130
  v_mov_b32 v39, v131
  v_mov_b32 v40, v96
  v_mov_b32 v41, v97
  v_mov_b32 v42, v98
  v_mov_b32 v43, v99
  s_set_gpr_idx_off
  s_mov_b64 exec, vcc
  ds_write_b128 v52, v[36:39]
  ds_write_b128 v52, v[40:43] offset:16
  s_mov_b64 exec, -1
L_ns_37:
  v_readlane_b32 s51, v182, 1
  v_mov_b32 v52, 151904
  s_nop 2
  s_bfe_u32 s58, s51, 0x20006
  s_cmp_lg_u32 s58, s43
  s_cbranch_scc1 L_ns_38
  s_lshr_b32 s58, s51, 8
  s_lshl_b32 s58, s58, 2
  s_and_b32 s51, s51, 255
  v_cmp_eq_u32 vcc, s51, v5
  s_set_gpr_idx_on s58, gpr_idx(SRC0)
  v_mov_b32 v36, v128
  v_mov_b32 v37, v129
  v_mov_b32 v38, v130
  v_mov_b32 v39, v131
  v_mov_b32 v40, v96
  v_mov_b32 v41, v97
  v_mov_b32 v42, v98
  v_mov_b32 v43, v99
  s_set_gpr_idx_off
  s_mov_b64 exec, vcc
  ds_write_b128 v52, v[36:39]
  ds_write_b128 v52, v[40:43] offset:16
  s_mov_b64 exec, -1
L_ns_38:
  v_readlane_b32 s51, v182, 2
  v_mov_b32 v52, 151936
  s_nop 2
  s_bfe_u32 s58, s51, 0x20006
  s_cmp_lg_u32 s58, s43
  s_cbranch_scc1 L_ns_39
  s_lshr_b32 s58, s51, 8
  s_lshl_b32 s58, s58, 2
  s_and_b32 s51, s51, 255
  v_cmp_eq_u32 vcc, s51, v5
  s_set_gpr_idx_on s58, gpr_idx(SRC0)
  v_mov_b32 v36, v128
  v_mov_b32 v37, v129
  v_mov_b32 v38, v130
  v_mov_b32 v39, v131
  v_mov_b32 v40, v96
  v_mov_b32 v41, v97
  v_mov_b32 v42, v98
  v_mov_b32 v43, v99
  s_set_gpr_idx_off
  s_mov_b64 exec, vcc
  ds_write_b128 v52, v[36:39]
  ds_write_b128 v52, v[40:43] offset:16
  s_mov_b64 exec, -1
L_ns_39:
  v_readlane_b32 s51, v182, 3
  v_mov_b32 v52, 151968
  s_nop 2
  s_bfe_u32 s58, s51, 0x20006
  s_cmp_lg_u32 s58, s43
  s_cbranch_scc1 L_ns_40
  s_lshr_b32 s58, s51, 8
  s_lshl_b32 s58, s58, 2
  s_and_b32 s51, s51, 255
  v_cmp_eq_u32 vcc, s51, v5
  s_set_gpr_idx_on s58, gpr_idx(SRC0)
  v_mov_b32 v36, v128
  v_mov_b32 v37, v129
  v_mov_b32 v38, v130
  v_mov_b32 v39, v131
  v_mov_b32 v40, v96
  v_mov_b32 v41, v97
  v_mov_b32 v42, v98
  v_mov_b32 v43, v99
  s_set_gpr_idx_off
  s_mov_b64 exec, vcc
  ds_write_b128 v52, v[36:39]
  ds_write_b128 v52, v[40:43] offset:16
  s_mov_b64 exec, -1
L_ns_40:
  v_readlane_b32 s51, v182, 4
  v_mov_b32 v52, 152000
  s_nop 2
  s_bfe_u32 s58, s51, 0x20006
  s_cmp_lg_u32 s58, s43
  s_cbranch_scc1 L_ns_41
  s_lshr_b32 s58, s51, 8
  s_lshl_b32 s58, s58, 2
  s_and_b32 s51, s51, 255
  v_cmp_eq_u32 vcc, s51, v5
  s_set_gpr_idx_on s58, gpr_idx(SRC0)
  v_mov_b32 v36, v128
  v_mov_b32 v37, v129
  v_mov_b32 v38, v130
  v_mov_b32 v39, v131
  v_mov_b32 v40, v96
  v_mov_b32 v41, v97
  v_mov_b32 v42, v98
  v_mov_b32 v43, v99
  s_set_gpr_idx_off
  s_mov_b64 exec, vcc
  ds_write_b128 v52, v[36:39]
  ds_write_b128 v52, v[40:43] offset:16
  s_mov_b64 exec, -1
L_ns_41:
  v_readlane_b32 s51, v182, 5
  v_mov_b32 v52, 152032
  s_nop 2
  s_bfe_u32 s58, s51, 0x20006
  s_cmp_lg_u32 s58, s43
  s_cbranch_scc1 L_ns_42
  s_lshr_b32 s58, s51, 8
  s_lshl_b32 s58, s58, 2
  s_and_b32 s51, s51, 255
  v_cmp_eq_u32 vcc, s51, v5
  s_set_gpr_idx_on s58, gpr_idx(SRC0)
  v_mov_b32 v36, v128
  v_mov_b32 v37, v129
  v_mov_b32 v38, v130
  v_mov_b32 v39, v131
  v_mov_b32 v40, v96
  v_mov_b32 v41, v97
  v_mov_b32 v42, v98
  v_mov_b32 v43, v99
  s_set_gpr_idx_off
  s_mov_b64 exec, vcc
  ds_write_b128 v52, v[36:39]
  ds_write_b128 v52, v[40:43] offset:16
  s_mov_b64 exec, -1
L_ns_42:
  v_readlane_b32 s51, v182, 6
  v_mov_b32 v52, 152064
  s_nop 2
  s_bfe_u32 s58, s51, 0x20006
  s_cmp_lg_u32 s58, s43
  s_cbranch_scc1 L_ns_43
  s_lshr_b32 s58, s51, 8
  s_lshl_b32 s58, s58, 2
  s_and_b32 s51, s51, 255
  v_cmp_eq_u32 vcc, s51, v5
  s_set_gpr_idx_on s58, gpr_idx(SRC0)
  v_mov_b32 v36, v128
  v_mov_b32 v37, v129
  v_mov_b32 v38, v130
  v_mov_b32 v39, v131
  v_mov_b32 v40, v96
  v_mov_b32 v41, v97
  v_mov_b32 v42, v98
  v_mov_b32 v43, v99
  s_set_gpr_idx_off
  s_mov_b64 exec, vcc
  ds_write_b128 v52, v[36:39]
  ds_write_b128 v52, v[40:43] offset:16
  s_mov_b64 exec, -1
L_ns_43:
  v_readlane_b32 s51, v182, 7
  v_mov_b32 v52, 152096
  s_nop 2
  s_bfe_u32 s58, s51, 0x20006
  s_cmp_lg_u32 s58, s43
  s_cbranch_scc1 L_ns_44
  s_lshr_b32 s58, s51, 8
  s_lshl_b32 s58, s58, 2
  s_and_b32 s51, s51, 255
  v_cmp_eq_u32 vcc, s51, v5
  s_set_gpr_idx_on s58, gpr_idx(SRC0)
  v_mov_b32 v36, v128
  v_mov_b32 v37, v129
  v_mov_b32 v38, v130
  v_mov_b32 v39, v131
  v_mov_b32 v40, v96
  v_mov_b32 v41, v97
  v_mov_b32 v42, v98
  v_mov_b32 v43, v99
  s_set_gpr_idx_off
  s_mov_b64 exec, vcc
  ds_write_b128 v52, v[36:39]
  ds_write_b128 v52, v[40:43] offset:16
  s_mov_b64 exec, -1
L_ns_44:
  s_waitcnt lgkmcnt(0)
  v_mov_b32 v11, 151808
  v_mov_b32 v12, 1
  s_mov_b64 exec, 1
  ds_add_u32 v11, v12 offset:24
  s_mov_b64 exec, -1
  s_cmp_lg_u32 s42, 4
  s_cbranch_scc1 L_hend_45
  v_lshlrev_b32 v18, 4, v1
  v_add_u32 v19, 152128, v18
  v_lshlrev_b32 v20, 5, v1
  v_add_u32 v53, 151872, v20
  s_movk_i32 s51, 1152
  v_mul_lo_u32 v44, v182, s51
  s_lshl_b32 s51, s41, 3
  v_add_u32 v44, s51, v44
  s_mov_b32 s52, 0
L_lw_46:
  ds_read_b32 v12, v11 offset:24
  s_add_u32 s52, s52, 1
  s_waitcnt lgkmcnt(0)
  s_cmp_gt_u32 s52, 1600000
  v_readfirstlane_b32 s51, v12
  s_cbranch_scc1 L_lwd_47
  s_nop 1
  s_cmp_ge_u32 s51, 4
  s_cbranch_scc1 L_lwd_47
  s_branch L_lw_46
L_lwd_47:
  s_mov_b64 exec, 0xff
  ds_read_b128 v[36:39], v53
  ds_read_b128 v[40:43], v53 offset:16
  s_mov_b64 exec, -1
  s_mov_b32 s52, 0
L_lw_48:
  ds_read_b32 v12, v11 offset:20
  s_add_u32 s52, s52, 1
  s_waitcnt lgkmcnt(0)
  s_cmp_gt_u32 s52, 1600000
  v_readfirstlane_b32 s51, v12
  s_cbranch_scc1 L_lwd_49
  s_nop 1
  s_cmp_ge_u32 s51, 4
  s_cbranch_scc1 L_lwd_49
  s_branch L_lw_48
L_lwd_49:
  s_mov_b64 exec, 0xff
  ds_read_b128 v[20:23], v19 offset:0
  ds_read_b128 v[24:27], v19 offset:128
  ds_read_b128 v[28:31], v19 offset:256
  ds_read_b128 v[32:35], v19 offset:384
  s_waitcnt lgkmcnt(0)
  v_add_f32 v20, v20, v24
  v_add_f32 v28, v28, v32
  v_add_f32 v21, v21, v25
  v_add_f32 v29, v29, v33
  v_add_f32 v22, v22, v26
  v_add_f32 v30, v30, v34
  v_add_f32 v23, v23, v27
  v_add_f32 v31, v31, v35
  v_add_f32 v20, v20, v28
  v_add_f32 v21, v21, v29
  v_add_f32 v22, v22, v30
  v_add_f32 v23, v23, v31
  v_fma_f32 v20, v20, v183, v36
  v_fma_f32 v21, v21, v183, v37
  v_fma_f32 v22, v22, v183, v38
  v_fma_f32 v23, v23, v183, v39
  s_nop 0
  v_cvt_pk_bf16_f32 v24, v20, v21
  v_cvt_pk_bf16_f32 v25, v22, v23
  buffer_store_dwordx2 v[24:25], v44, s[20:23], 0 offen
  s_mov_b64 exec, -1
L_hend_45:
  s_endpgm
L_cm_5:
  s_setprio 2
  s_mov_b32 s32, s80
  s_and_b32 s33, s81, 0xffff
  s_mov_b32 s34, 0x240000
  s_mov_b32 s35, 0x00020000
  v_and_b32 v1, 63, v0
  v_lshlrev_b32 v4, 4, v1
  s_add_u32 s56, s45, 33808
  s_lshl_b32 s57, s44, 12
  s_mov_b32 m0, s56
  s_lshl_b32 s51, s44, 1
  buffer_load_dwordx4 v4, s[32:35], s57 offen offset:0 nt lds
  buffer_load_dwordx4 v4, s[32:35], s57 offen offset:1024 nt lds
  buffer_load_dwordx4 v4, s[32:35], s57 offen offset:2048 nt lds
  buffer_load_dwordx4 v4, s[32:35], s57 offen offset:3072 nt lds
  s_add_u32 s56, s56, 4096
  s_add_u32 s57, s57, 4096
  s_mov_b32 m0, s56
  s_mov_b64 exec, 0x3
  buffer_load_dwordx4 v4, s[32:35], s57 offen nt lds
  s_mov_b64 exec, -1
  s_and_b32 s52, s51, 0xfffffffc
  s_add_u32 s54, s82, s52
  s_addc_u32 s55, s83, 0
  s_load_dword s53, s[54:55], 0
  v_and_b32 v2, 15, v0
  v_bfe_u32 v3, v0, 4, 2
  v_mov_b32 v12, 0
  v_mov_b32 v13, 0
  v_mov_b32 v14, 0
  v_mov_b32 v15, 0
  v_add_u32 v11, s45, v4
  s_mov_b32 exec_hi, 0
  ds_write_b128 v11, v[12:15] offset:33296
  s_mov_b64 exec, 0x3
  ds_write_b128 v11, v[12:15]
  s_mov_b64 exec, 0xf
  ds_write_b128 v11, v[12:15] offset:4128
  s_mov_b64 exec, -1
  v_lshlrev_b32 v5, 5, v2
  v_lshl_add_u32 v5, v3, 4, v5
  v_add_u32 v5, s45, v5
  v_add_u32 v5, 33296, v5
  v_and_b32 v8, 7, v2
  v_sub_u32 v8, 7, v8
  v_mul_u32_u24 v8, 4160, v8
  v_lshrrev_b32 v6, 3, v2
  v_sub_u32 v6, v3, v6
  v_lshlrev_b32 v6, 4, v6
  v_add_u32 v8, v8, v6
  v_add_u32 v8, 16, v8
  v_add_u32 v9, s45, v8
  v_lshlrev_b32 v6, 5, v2
  v_lshl_add_u32 v6, v3, 3, v6
  v_sub_u32 v7, 536, v6
  v_add_u32 v7, s45, v7
  v_add_u32 v6, s45, v6
  v_add_u32 v6, 33296, v6
  s_lshl_b32 s49, s43, 2
  s_add_u32 s49, s49, 151808
  v_mov_b32 v10, s49
  v_mov_b32 v88, 0
  v_mov_b32 v89, 0
  v_mov_b32 v90, 0
  v_mov_b32 v91, 0
  v_mov_b32 v92, 0
  v_mov_b32 v93, 0
  v_mov_b32 v94, 0
  v_mov_b32 v95, 0
  v_mov_b32 v96, 0
  v_mov_b32 v97, 0
  v_mov_b32 v98, 0
  v_mov_b32 v99, 0
  v_mov_b32 v100, 0
  v_mov_b32 v101, 0
  v_mov_b32 v102, 0
  v_mov_b32 v103, 0
  v_mov_b32 v104, 0
  v_mov_b32 v105, 0
  v_mov_b32 v106, 0
  v_mov_b32 v107, 0
  v_mov_b32 v108, 0
  v_mov_b32 v109, 0
  v_mov_b32 v110, 0
  v_mov_b32 v111, 0
  v_mov_b32 v112, 0
  v_mov_b32 v113, 0
  v_mov_b32 v114, 0
  v_mov_b32 v115, 0
  v_mov_b32 v116, 0
  v_mov_b32 v117, 0
  v_mov_b32 v118, 0
  v_mov_b32 v119, 0
  s_lshl_b32 s48, s44, 12
  s_add_u32 s48, s48, 131072
  v_lshlrev_b32 v16, 3, v3
  s_lshl_b32 s50, s44, 7
  s_add_u32 s50, s50, 4194304
  v_and_b32 v17, 15, v1
  v_lshlrev_b32 v17, 3, v17
  s_sleep 24
  s_mov_b32 s52, 0
L_urp_50:
  buffer_load_dwordx4 v[120:123], v4, s[36:39], s48 offen offset:0 sc1
  buffer_load_dwordx4 v[124:127], v4, s[36:39], s48 offen offset:1024 sc1
  buffer_load_dwordx4 v[128:131], v4, s[36:39], s48 offen offset:2048 sc1
  buffer_load_dwordx4 v[132:135], v4, s[36:39], s48 offen offset:3072 sc1
  buffer_load_dword v136, v16, s[36:39], s50 offen offset:0 sc1
  buffer_load_dword v137, v16, s[36:39], s50 offen offset:32 sc1
  buffer_load_dword v138, v16, s[36:39], s50 offen offset:64 sc1
  buffer_load_dword v139, v16, s[36:39], s50 offen offset:96 sc1
  s_waitcnt vmcnt(0)
  v_xor_b32 v140, v120, v121
  v_xor_b32 v141, v124, v125
  v_xor_b32 v142, v128, v129
  v_xor_b32 v143, v132, v133
  v_xor_b32 v144, v122, v123
  v_xor_b32 v145, v126, v127
  v_xor_b32 v146, v130, v131
  v_xor_b32 v147, v134, v135
  v_xor_b32 v140, v140, v144
  v_xor_b32 v141, v141, v145
  v_xor_b32 v142, v142, v146
  v_xor_b32 v143, v143, v147
  v_xor_b32_dpp v140, v140, v140 quad_perm:[1,0,3,2] row_mask:0xf bank_mask:0xf
  v_xor_b32_dpp v141, v141, v141 quad_perm:[1,0,3,2] row_mask:0xf bank_mask:0xf
  v_xor_b32_dpp v142, v142, v142 quad_perm:[1,0,3,2] row_mask:0xf bank_mask:0xf
  v_xor_b32_dpp v143, v143, v143 quad_perm:[1,0,3,2] row_mask:0xf bank_mask:0xf
  v_xor_b32_dpp v140, v140, v140 quad_perm:[2,3,0,1] row_mask:0xf bank_mask:0xf
  v_xor_b32_dpp v141, v141, v141 quad_perm:[2,3,0,1] row_mask:0xf bank_mask:0xf
  v_xor_b32_dpp v142, v142, v142 quad_perm:[2,3,0,1] row_mask:0xf bank_mask:0xf
  v_xor_b32_dpp v143, v143, v143 quad_perm:[2,3,0,1] row_mask:0xf bank_mask:0xf
  v_xor_b32_dpp v140, v140, v140 row_half_mirror row_mask:0xf bank_mask:0xf
  v_xor_b32_dpp v141, v141, v141 row_half_mirror row_mask:0xf bank_mask:0xf
  v_xor_b32_dpp v142, v142, v142 row_half_mirror row_mask:0xf bank_mask:0xf
  v_xor_b32_dpp v143, v143, v143 row_half_mirror row_mask:0xf bank_mask:0xf
  v_xor_b32_dpp v140, v140, v140 row_mirror row_mask:0xf bank_mask:0xf
  v_xor_b32_dpp v141, v141, v141 row_mirror row_mask:0xf bank_mask:0xf
  v_xor_b32_dpp v142, v142, v142 row_mirror row_mask:0xf bank_mask:0xf
  v_xor_b32_dpp v143, v143, v143 row_mirror row_mask:0xf bank_mask:0xf
  v_xor_b32 v140, v140, v136
  v_xor_b32 v141, v141, v137
  v_xor_b32 v142, v142, v138
  v_xor_b32 v143, v143, v139
  v_cmp_eq_u32 vcc, s46, v140
  v_cmp_eq_u32 s[54:55], s46, v141
  s_and_b64 vcc, vcc, s[54:55]
  v_cmp_eq_u32 s[54:55], s46, v142
  s_and_b64 vcc, vcc, s[54:55]
  v_cmp_eq_u32 s[54:55], s46, v143
  s_and_b64 vcc, vcc, s[54:55]
  s_andn2_b64 exec, exec, vcc
  s_cbranch_scc0 L_urok_51
  s_add_u32 s52, s52, 1
  s_cmp_gt_u32 s52, 200000
  s_cbranch_scc1 L_urok_51
  s_sleep 6
  s_branch L_urp_50
L_urok_51:
  s_mov_b64 exec, -1
  s_setprio 0
  ds_write_b128 v11, v[120:123] offset:32
  ds_write_b128 v11, v[124:127] offset:1056
  ds_write_b128 v11, v[128:131] offset:2080
  ds_write_b128 v11, v[132:135] offset:3104
  s_waitcnt lgkmcnt(0)
  ds_read_b128 v[152:155], v11 offset:4096
  ds_read_b128 v[156:159], v11 offset:4112
  ds_read_b128 v[160:163], v11 offset:3072
  ds_read_b128 v[164:167], v11 offset:3088
  ds_read_b128 v[168:171], v11 offset:2048
  ds_read_b128 v[172:175], v11 offset:2064
  ds_read_b128 v[20:23], v11 offset:1024
  ds_read_b128 v[24:27], v11 offset:1040
  ds_read_b128 v[28:31], v11 offset:0
  ds_read_b128 v[32:35], v11 offset:16
  s_waitcnt lgkmcnt(8)
  s_mov_b64 exec, 0x1f
  v_alignbit_b32 v36, v153, v152, 16
  v_alignbit_b32 v37, v154, v153, 16
  v_alignbit_b32 v38, v155, v154, 16
  v_alignbit_b32 v39, v156, v155, 16
  v_alignbit_b32 v40, v157, v156, 16
  v_alignbit_b32 v41, v158, v157, 16
  v_alignbit_b32 v42, v159, v158, 16
  ds_write_b128 v11, v[154:157] offset:20736
  v_pk_mov_b32 v[44:45], v[152:153], v[154:155] op_sel:[1,0]
  v_pk_mov_b32 v[46:47], v[154:155], v[156:157] op_sel:[1,0]
  v_pk_mov_b32 v[48:49], v[156:157], v[158:159] op_sel:[1,0]
  ds_write_b128 v11, v[36:39] offset:8256
  ds_write_b128 v11, v[38:41] offset:24896
  v_pk_mov_b32 v[50:51], v[36:37], v[38:39] op_sel:[1,0]
  v_pk_mov_b32 v[52:53], v[38:39], v[40:41] op_sel:[1,0]
  v_pk_mov_b32 v[54:55], v[40:41], v[42:43] op_sel:[1,0]
  ds_write_b128 v11, v[44:47] offset:12416
  ds_write_b128 v11, v[46:49] offset:29056
  s_nop 0
  ds_write_b128 v11, v[50:53] offset:16576
  ds_write_b128 v11, v[52:55] offset:33216
  s_mov_b64 exec, -1
  s_waitcnt lgkmcnt(11)
  v_alignbit_b32 v36, v161, v160, 16
  v_alignbit_b32 v37, v162, v161, 16
  v_alignbit_b32 v38, v163, v162, 16
  v_alignbit_b32 v39, v164, v163, 16
  v_alignbit_b32 v40, v165, v164, 16
  v_alignbit_b32 v41, v166, v165, 16
  v_alignbit_b32 v42, v167, v166, 16
  ds_write_b128 v11, v[162:165] offset:19712
  v_pk_mov_b32 v[44:45], v[160:161], v[162:163] op_sel:[1,0]
  v_pk_mov_b32 v[46:47], v[162:163], v[164:165] op_sel:[1,0]
  v_pk_mov_b32 v[48:49], v[164:165], v[166:167] op_sel:[1,0]
  ds_write_b128 v11, v[36:39] offset:7232
  ds_write_b128 v11, v[38:41] offset:23872
  v_pk_mov_b32 v[50:51], v[36:37], v[38:39] op_sel:[1,0]
  v_pk_mov_b32 v[52:53], v[38:39], v[40:41] op_sel:[1,0]
  v_pk_mov_b32 v[54:55], v[40:41], v[42:43] op_sel:[1,0]
  ds_write_b128 v11, v[44:47] offset:11392
  ds_write_b128 v11, v[46:49] offset:28032
  s_nop 0
  ds_write_b128 v11, v[50:53] offset:15552
  ds_write_b128 v11, v[52:55] offset:32192
  s_waitcnt lgkmcnt(14)
  v_alignbit_b32 v36, v169, v168, 16
  v_alignbit_b32 v37, v170, v169, 16
  v_alignbit_b32 v38, v171, v170, 16
  v_alignbit_b32 v39, v172, v171, 16
  v_alignbit_b32 v40, v173, v172, 16
  v_alignbit_b32 v41, v174, v173, 16
  v_alignbit_b32 v42, v175, v174, 16
  ds_write_b128 v11, v[170:173] offset:18688
  v_pk_mov_b32 v[44:45], v[168:169], v[170:171] op_sel:[1,0]
  v_pk_mov_b32 v[46:47], v[170:171], v[172:173] op_sel:[1,0]
  v_pk_mov_b32 v[48:49], v[172:173], v[174:175] op_sel:[1,0]
  ds_write_b128 v11, v[36:39] offset:6208
  ds_write_b128 v11, v[38:41] offset:22848
  v_pk_mov_b32 v[50:51], v[36:37], v[38:39] op_sel:[1,0]
  v_pk_mov_b32 v[52:53], v[38:39], v[40:41] op_sel:[1,0]
  v_pk_mov_b32 v[54:55], v[40:41], v[42:43] op_sel:[1,0]
  ds_write_b128 v11, v[44:47] offset:10368
  ds_write_b128 v11, v[46:49] offset:27008
  s_nop 0
  ds_write_b128 v11, v[50:53] offset:14528
  ds_write_b128 v11, v[52:55] offset:31168
  s_waitcnt lgkmcnt(0)
  ds_read_b128 v[64:67], v9 offset:4096
  ds_read_b128 v[248:251], v5 offset:2048
  ds_read_b128 v[216:219], v5 offset:2560
  ds_read_b128 v[184:187], v5 offset:3072
  ds_read_b128 v[152:155], v5 offset:3584
  ds_read_b128 v[120:123], v5 offset:4096
  ds_read_b128 v[68:71], v9 offset:4032
  ds_read_b128 v[220:223], v5 offset:2496
  ds_read_b128 v[72:75], v9 offset:3968
  ds_read_b128 v[188:191], v5 offset:3008
  ds_read_b128 v[76:79], v9 offset:3904
  ds_read_b128 v[156:159], v5 offset:3520
  ds_read_b128 v[80:83], v9 offset:3840
  ds_read_b128 v[124:127], v5 offset:4032
  ds_read_b128 v[84:87], v9 offset:3776
  ds_read_b128 v[224:227], v5 offset:2432
  s_and_b32 s52, s51, 2
  s_lshl_b32 s52, s52, 3
  s_lshr_b32 s53, s53, s52
  s_lshl_b32 s53, s53, 16
  v_mov_b32 v18, s53
  v_mov_b32 v19, s53
  ds_read_b128 v[192:195], v5 offset:2944
  ds_read_b128 v[160:163], v5 offset:3456
  ds_read_b128 v[128:131], v5 offset:3968
  ds_read_b128 v[228:231], v5 offset:2368
  ds_read_b128 v[196:199], v5 offset:2880
  ds_read_b128 v[164:167], v5 offset:3392
  ds_read_b128 v[132:135], v5 offset:3904
  s_waitcnt lgkmcnt(15)
  v_mfma_f32_16x16x32_bf16 v[100:103], v[64:67], v[248:251], v[100:103]
  v_mfma_f32_16x16x32_bf16 v[104:107], v[64:67], v[216:219], v[104:107]
  v_mfma_f32_16x16x32_bf16 v[108:111], v[64:67], v[184:187], v[108:111]
  v_mfma_f32_16x16x32_bf16 v[112:115], v[64:67], v[152:155], v[112:115]
  v_mfma_f32_16x16x32_bf16 v[116:119], v[64:67], v[120:123], v[116:119]
  ds_read_b128 v[64:67], v9 offset:3712
  ds_read_b128 v[120:123], v5 offset:512
  ds_read_b128 v[232:235], v5 offset:2304
  ds_read_b128 v[200:203], v5 offset:2816
  ds_read_b128 v[168:171], v5 offset:3328
  ds_read_b128 v[136:139], v5 offset:3840
  s_waitcnt lgkmcnt(15)
  v_mfma_f32_16x16x32_bf16 v[104:107], v[68:71], v[220:223], v[104:107]
  v_mfma_f32_16x16x32_bf16 v[108:111], v[68:71], v[188:191], v[108:111]
  v_mfma_f32_16x16x32_bf16 v[112:115], v[68:71], v[156:159], v[112:115]
  v_mfma_f32_16x16x32_bf16 v[116:119], v[68:71], v[124:127], v[116:119]
  ds_read_b128 v[68:71], v9 offset:3648
  ds_read_b128 v[124:127], v5 offset:1024
  ds_read_b128 v[236:239], v5 offset:2240
  ds_read_b128 v[204:207], v5 offset:2752
  ds_read_b128 v[172:175], v5 offset:3264
  ds_read_b128 v[140:143], v5 offset:3776
  s_waitcnt lgkmcnt(15)
  v_mfma_f32_16x16x32_bf16 v[104:107], v[72:75], v[224:227], v[104:107]
  v_mfma_f32_16x16x32_bf16 v[108:111], v[72:75], v[192:195], v[108:111]
  v_mfma_f32_16x16x32_bf16 v[112:115], v[72:75], v[160:163], v[112:115]
  v_mfma_f32_16x16x32_bf16 v[116:119], v[72:75], v[128:131], v[116:119]
  ds_read_b128 v[72:75], v9 offset:3584
  ds_read_b128 v[128:131], v5 offset:1536
  ds_read_b128 v[240:243], v5 offset:2176
  ds_read_b128 v[208:211], v5 offset:2688
  ds_read_b128 v[176:179], v5 offset:3200
  ds_read_b128 v[144:147], v5 offset:3712
  s_waitcnt lgkmcnt(15)
  v_mfma_f32_16x16x32_bf16 v[104:107], v[76:79], v[228:231], v[104:107]
  v_mfma_f32_16x16x32_bf16 v[108:111], v[76:79], v[196:199], v[108:111]
  v_mfma_f32_16x16x32_bf16 v[112:115], v[76:79], v[164:167], v[112:115]
  v_mfma_f32_16x16x32_bf16 v[116:119], v[76:79], v[132:135], v[116:119]
  ds_read_b128 v[76:79], v9 offset:3520
  ds_read_b128 v[132:135], v5 offset:448
  ds_read_b128 v[244:247], v5 offset:2112
  ds_read_b128 v[212:215], v5 offset:2624
  ds_read_b128 v[180:183], v5 offset:3136
  ds_read_b128 v[148:151], v5 offset:3648
  s_waitcnt lgkmcnt(15)
  v_mfma_f32_16x16x32_bf16 v[104:107], v[80:83], v[232:235], v[104:107]
  v_mfma_f32_16x16x32_bf16 v[108:111], v[80:83], v[200:203], v[108:111]
  v_mfma_f32_16x16x32_bf16 v[112:115], v[80:83], v[168:171], v[112:115]
  v_mfma_f32_16x16x32_bf16 v[116:119], v[80:83], v[136:139], v[116:119]
  ds_read_b128 v[80:83], v9 offset:3456
  ds_read_b128 v[136:139], v5 offset:960
  s_waitcnt lgkmcnt(14)
  v_mfma_f32_16x16x32_bf16 v[104:107], v[84:87], v[236:239], v[104:107]
  v_mfma_f32_16x16x32_bf16 v[108:111], v[84:87], v[204:207], v[108:111]
  v_mfma_f32_16x16x32_bf16 v[112:115], v[84:87], v[172:175], v[112:115]
  v_mfma_f32_16x16x32_bf16 v[116:119], v[84:87], v[140:143], v[116:119]
  ds_read_b128 v[84:87], v9 offset:3392
  ds_read_b128 v[140:143], v5 offset:1472
  s_waitcnt lgkmcnt(10)
  v_mfma_f32_16x16x32_bf16 v[104:107], v[64:67], v[240:243], v[104:107]
  v_mfma_f32_16x16x32_bf16 v[108:111], v[64:67], v[208:211], v[108:111]
  v_mfma_f32_16x16x32_bf16 v[112:115], v[64:67], v[176:179], v[112:115]
  v_mfma_f32_16x16x32_bf16 v[116:119], v[64:67], v[144:147], v[116:119]
  ds_read_b128 v[64:67], v9 offset:3328
  ds_read_b128 v[144:147], v5 offset:1984
  s_waitcnt lgkmcnt(6)
  v_mfma_f32_16x16x32_bf16 v[104:107], v[68:71], v[244:247], v[104:107]
  v_mfma_f32_16x16x32_bf16 v[108:111], v[68:71], v[212:215], v[108:111]
  v_mfma_f32_16x16x32_bf16 v[112:115], v[68:71], v[180:183], v[112:115]
  v_mfma_f32_16x16x32_bf16 v[116:119], v[68:71], v[148:151], v[116:119]
  ds_read_b128 v[68:71], v9 offset:3264
  ds_read_b128 v[148:151], v5 offset:384
  s_waitcnt lgkmcnt(15)
  v_mfma_f32_16x16x32_bf16 v[104:107], v[72:75], v[248:251], v[104:107]
  v_mfma_f32_16x16x32_bf16 v[108:111], v[72:75], v[216:219], v[108:111]
  v_mfma_f32_16x16x32_bf16 v[112:115], v[72:75], v[184:187], v[112:115]
  v_mfma_f32_16x16x32_bf16 v[116:119], v[72:75], v[152:155], v[116:119]
  ds_read_b128 v[72:75], v9 offset:3200
  ds_read_b128 v[152:155], v5 offset:896
  s_waitcnt lgkmcnt(15)
  v_mfma_f32_16x16x32_bf16 v[108:111], v[76:79], v[220:223], v[108:111]
  v_mfma_f32_16x16x32_bf16 v[112:115], v[76:79], v[188:191], v[112:115]
  v_mfma_f32_16x16x32_bf16 v[116:119], v[76:79], v[156:159], v[116:119]
  ds_read_b128 v[76:79], v9 offset:3136
  ds_read_b128 v[156:159], v5 offset:1408
  s_waitcnt lgkmcnt(11)
  v_mfma_f32_16x16x32_bf16 v[108:111], v[80:83], v[224:227], v[108:111]
  v_mfma_f32_16x16x32_bf16 v[112:115], v[80:83], v[192:195], v[112:115]
  v_mfma_f32_16x16x32_bf16 v[116:119], v[80:83], v[160:163], v[116:119]
  ds_read_b128 v[80:83], v9 offset:3072
  ds_read_b128 v[160:163], v5 offset:1920
  s_waitcnt lgkmcnt(11)
  v_mfma_f32_16x16x32_bf16 v[108:111], v[84:87], v[228:231], v[108:111]
  v_mfma_f32_16x16x32_bf16 v[112:115], v[84:87], v[196:199], v[112:115]
  v_mfma_f32_16x16x32_bf16 v[116:119], v[84:87], v[164:167], v[116:119]
  ds_read_b128 v[84:87], v9 offset:3008
  ds_read_b128 v[164:167], v5 offset:320
  s_waitcnt lgkmcnt(11)
  v_mfma_f32_16x16x32_bf16 v[108:111], v[64:67], v[232:235], v[108:111]
  v_mfma_f32_16x16x32_bf16 v[112:115], v[64:67], v[200:203], v[112:115]
  v_mfma_f32_16x16x32_bf16 v[116:119], v[64:67], v[168:171], v[116:119]
  ds_read_b128 v[64:67], v9 offset:2944
  ds_read_b128 v[168:171], v5 offset:832
  s_waitcnt lgkmcnt(11)
  v_mfma_f32_16x16x32_bf16 v[108:111], v[68:71], v[236:239], v[108:111]
  v_mfma_f32_16x16x32_bf16 v[112:115], v[68:71], v[204:207], v[112:115]
  v_mfma_f32_16x16x32_bf16 v[116:119], v[68:71], v[172:175], v[116:119]
  ds_read_b128 v[68:71], v9 offset:2880
  ds_read_b128 v[172:175], v5 offset:1344
  s_waitcnt lgkmcnt(11)
  v_mfma_f32_16x16x32_bf16 v[108:111], v[72:75], v[240:243], v[108:111]
  v_mfma_f32_16x16x32_bf16 v[112:115], v[72:75], v[208:211], v[112:115]
  v_mfma_f32_16x16x32_bf16 v[116:119], v[72:75], v[176:179], v[116:119]
  ds_read_b128 v[72:75], v9 offset:2816
  ds_read_b128 v[176:179], v5 offset:1856
  s_waitcnt lgkmcnt(11)
  v_mfma_f32_16x16x32_bf16 v[108:111], v[76:79], v[244:247], v[108:111]
  v_mfma_f32_16x16x32_bf16 v[112:115], v[76:79], v[212:215], v[112:115]
  v_mfma_f32_16x16x32_bf16 v[116:119], v[76:79], v[180:183], v[116:119]
  ds_read_b128 v[76:79], v9 offset:2752
  ds_read_b128 v[180:183], v5 offset:256
  s_waitcnt lgkmcnt(11)
  v_mfma_f32_16x16x32_bf16 v[108:111], v[80:83], v[248:251], v[108:111]
  v_mfma_f32_16x16x32_bf16 v[112:115], v[80:83], v[216:219], v[112:115]
  v_mfma_f32_16x16x32_bf16 v[116:119], v[80:83], v[184:187], v[116:119]
  ds_read_b128 v[80:83], v9 offset:2688
  ds_read_b128 v[184:187], v5 offset:768
  s_waitcnt lgkmcnt(11)
  v_mfma_f32_16x16x32_bf16 v[112:115], v[84:87], v[220:223], v[112:115]
  v_mfma_f32_16x16x32_bf16 v[116:119], v[84:87], v[188:191], v[116:119]
  ds_read_b128 v[84:87], v9 offset:2624
  ds_read_b128 v[188:191], v5 offset:1280
  s_waitcnt lgkmcnt(11)
  v_mfma_f32_16x16x32_bf16 v[112:115], v[64:67], v[224:227], v[112:115]
  v_mfma_f32_16x16x32_bf16 v[116:119], v[64:67], v[192:195], v[116:119]
  ds_read_b128 v[64:67], v9 offset:2560
  ds_read_b128 v[192:195], v5 offset:1792
  s_waitcnt lgkmcnt(11)
  v_mfma_f32_16x16x32_bf16 v[112:115], v[68:71], v[228:231], v[112:115]
  v_mfma_f32_16x16x32_bf16 v[116:119], v[68:71], v[196:199], v[116:119]
  ds_read_b128 v[68:71], v9 offset:2496
  ds_read_b128 v[196:199], v5 offset:192
  s_waitcnt lgkmcnt(11)
  v_mfma_f32_16x16x32_bf16 v[112:115], v[72:75], v[232:235], v[112:115]
  v_mfma_f32_16x16x32_bf16 v[116:119], v[72:75], v[200:203], v[116:119]
  ds_read_b128 v[72:75], v9 offset:2432
  ds_read_b128 v[200:203], v5 offset:704
  s_waitcnt lgkmcnt(11)
  v_mfma_f32_16x16x32_bf16 v[112:115], v[76:79], v[236:239], v[112:115]
  v_mfma_f32_16x16x32_bf16 v[116:119], v[76:79], v[204:207], v[116:119]
  ds_read_b128 v[76:79], v9 offset:2368
  ds_read_b128 v[204:207], v5 offset:1216
  s_waitcnt lgkmcnt(11)
  v_mfma_f32_16x16x32_bf16 v[112:115], v[80:83], v[240:243], v[112:115]
  v_mfma_f32_16x16x32_bf16 v[116:119], v[80:83], v[208:211], v[116:119]
  ds_read_b128 v[80:83], v9 offset:2304
  ds_read_b128 v[208:211], v5 offset:1728
  s_waitcnt lgkmcnt(11)
  v_mfma_f32_16x16x32_bf16 v[112:115], v[84:87], v[244:247], v[112:115]
  v_mfma_f32_16x16x32_bf16 v[116:119], v[84:87], v[212:215], v[116:119]
  ds_read_b128 v[84:87], v9 offset:2240
  ds_read_b128 v[212:215], v5 offset:128
  s_waitcnt lgkmcnt(11)
  v_mfma_f32_16x16x32_bf16 v[112:115], v[64:67], v[248:251], v[112:115]
  v_mfma_f32_16x16x32_bf16 v[116:119], v[64:67], v[216:219], v[116:119]
  ds_read_b128 v[64:67], v9 offset:2176
  ds_read_b128 v[216:219], v5 offset:640
  s_waitcnt lgkmcnt(11)
  v_mfma_f32_16x16x32_bf16 v[116:119], v[68:71], v[220:223], v[116:119]
  ds_read_b128 v[68:71], v9 offset:2112
  ds_read_b128 v[220:223], v5 offset:1152
  s_waitcnt lgkmcnt(11)
  v_mfma_f32_16x16x32_bf16 v[116:119], v[72:75], v[224:227], v[116:119]
  ds_read_b128 v[72:75], v9 offset:2048
  ds_read_b128 v[224:227], v5 offset:1664
  s_waitcnt lgkmcnt(11)
  v_mfma_f32_16x16x32_bf16 v[116:119], v[76:79], v[228:231], v[116:119]
  ds_read_b128 v[76:79], v9 offset:4096
  ds_read_b128 v[228:231], v5 offset:64
  s_waitcnt lgkmcnt(11)
  v_mfma_f32_16x16x32_bf16 v[116:119], v[80:83], v[232:235], v[116:119]
  ds_read_b128 v[80:83], v9 offset:4032
  ds_read_b128 v[232:235], v5 offset:576
  s_waitcnt lgkmcnt(11)
  v_mfma_f32_16x16x32_bf16 v[116:119], v[84:87], v[236:239], v[116:119]
  ds_read_b128 v[84:87], v9 offset:3968
  ds_read_b128 v[236:239], v5 offset:1088
  s_waitcnt lgkmcnt(11)
  v_mfma_f32_16x16x32_bf16 v[116:119], v[64:67], v[240:243], v[116:119]
  ds_read_b128 v[64:67], v9 offset:3904
  ds_read_b128 v[240:243], v5 offset:1600
  s_waitcnt lgkmcnt(11)
  v_mfma_f32_16x16x32_bf16 v[116:119], v[68:71], v[244:247], v[116:119]
  ds_read_b128 v[68:71], v9 offset:3840
  ds_read_b128 v[244:247], v5 offset:0
  s_waitcnt lgkmcnt(11)
  v_mfma_f32_16x16x32_bf16 v[116:119], v[72:75], v[248:251], v[116:119]
  ds_read_b128 v[72:75], v9 offset:3776
  s_waitcnt lgkmcnt(10)
  v_mfma_f32_16x16x32_bf16 v[88:91], v[76:79], v[120:123], v[88:91]
  v_alignbit_b32 v36, v21, v20, 16
  v_alignbit_b32 v37, v22, v21, 16
  v_mfma_f32_16x16x32_bf16 v[92:95], v[76:79], v[124:127], v[92:95]
  v_alignbit_b32 v38, v23, v22, 16
  v_alignbit_b32 v39, v24, v23, 16
  v_mfma_f32_16x16x32_bf16 v[96:99], v[76:79], v[128:131], v[96:99]
  ds_read_b128 v[76:79], v9 offset:3712
  s_waitcnt lgkmcnt(9)
  v_mfma_f32_16x16x32_bf16 v[88:91], v[80:83], v[132:135], v[88:91]
  v_alignbit_b32 v40, v25, v24, 16
  v_alignbit_b32 v41, v26, v25, 16
  v_mfma_f32_16x16x32_bf16 v[92:95], v[80:83], v[136:139], v[92:95]
  v_alignbit_b32 v42, v27, v26, 16
  ds_write_b128 v11, v[22:25] offset:17664
  v_mfma_f32_16x16x32_bf16 v[96:99], v[80:83], v[140:143], v[96:99]
  v_pk_mov_b32 v[44:45], v[20:21], v[22:23] op_sel:[1,0]
  v_pk_mov_b32 v[46:47], v[22:23], v[24:25] op_sel:[1,0]
  v_mfma_f32_16x16x32_bf16 v[100:103], v[80:83], v[144:147], v[100:103]
  ds_read_b128 v[80:83], v9 offset:3648
  s_waitcnt lgkmcnt(9)
  v_mfma_f32_16x16x32_bf16 v[88:91], v[84:87], v[148:151], v[88:91]
  v_pk_mov_b32 v[48:49], v[24:25], v[26:27] op_sel:[1,0]
  ds_write_b128 v11, v[36:39] offset:5184
  v_mfma_f32_16x16x32_bf16 v[92:95], v[84:87], v[152:155], v[92:95]
  ds_write_b128 v11, v[38:41] offset:21824
  v_pk_mov_b32 v[50:51], v[36:37], v[38:39] op_sel:[1,0]
  v_mfma_f32_16x16x32_bf16 v[96:99], v[84:87], v[156:159], v[96:99]
  v_pk_mov_b32 v[52:53], v[38:39], v[40:41] op_sel:[1,0]
  v_pk_mov_b32 v[54:55], v[40:41], v[42:43] op_sel:[1,0]
  v_mfma_f32_16x16x32_bf16 v[100:103], v[84:87], v[160:163], v[100:103]
  ds_read_b128 v[84:87], v9 offset:3584
  s_waitcnt lgkmcnt(10)
  v_mfma_f32_16x16x32_bf16 v[88:91], v[64:67], v[164:167], v[88:91]
  ds_write_b128 v11, v[44:47] offset:9344
  ds_write_b128 v11, v[46:49] offset:25984
  v_mfma_f32_16x16x32_bf16 v[92:95], v[64:67], v[168:171], v[92:95]
  s_nop 0
  ds_write_b128 v11, v[50:53] offset:13504
  v_mfma_f32_16x16x32_bf16 v[96:99], v[64:67], v[172:175], v[96:99]
  ds_write_b128 v11, v[52:55] offset:30144
  v_alignbit_b32 v36, v29, v28, 16
  v_mfma_f32_16x16x32_bf16 v[100:103], v[64:67], v[176:179], v[100:103]
  ds_read_b128 v[64:67], v9 offset:3520
  s_waitcnt lgkmcnt(13)
  v_mfma_f32_16x16x32_bf16 v[88:91], v[68:71], v[180:183], v[88:91]
  v_alignbit_b32 v37, v30, v29, 16
  v_alignbit_b32 v38, v31, v30, 16
  v_mfma_f32_16x16x32_bf16 v[92:95], v[68:71], v[184:187], v[92:95]
  v_alignbit_b32 v39, v32, v31, 16
  v_alignbit_b32 v40, v33, v32, 16
  v_mfma_f32_16x16x32_bf16 v[96:99], v[68:71], v[188:191], v[96:99]
  v_alignbit_b32 v41, v34, v33, 16
  v_alignbit_b32 v42, v35, v34, 16
  v_mfma_f32_16x16x32_bf16 v[100:103], v[68:71], v[192:195], v[100:103]
  ds_read_b128 v[68:71], v9 offset:3456
  ds_read_b64 v[56:57], v7 offset:3584
  s_waitcnt lgkmcnt(13)
  v_mfma_f32_16x16x32_bf16 v[88:91], v[72:75], v[196:199], v[88:91]
  ds_write_b128 v11, v[30:33] offset:16640
  v_pk_mov_b32 v[44:45], v[28:29], v[30:31] op_sel:[1,0]
  v_mfma_f32_16x16x32_bf16 v[92:95], v[72:75], v[200:203], v[92:95]
  v_pk_mov_b32 v[46:47], v[30:31], v[32:33] op_sel:[1,0]
  v_pk_mov_b32 v[48:49], v[32:33], v[34:35] op_sel:[1,0]
  v_mfma_f32_16x16x32_bf16 v[96:99], v[72:75], v[204:207], v[96:99]
  ds_write_b128 v11, v[36:39] offset:4160
  ds_write_b128 v11, v[38:41] offset:20800
  v_mfma_f32_16x16x32_bf16 v[100:103], v[72:75], v[208:211], v[100:103]
  ds_read_b128 v[72:75], v9 offset:3392
  s_waitcnt lgkmcnt(15)
  v_mfma_f32_16x16x32_bf16 v[88:91], v[76:79], v[212:215], v[88:91]
  v_pk_mov_b32 v[50:51], v[36:37], v[38:39] op_sel:[1,0]
  v_pk_mov_b32 v[52:53], v[38:39], v[40:41] op_sel:[1,0]
  v_mfma_f32_16x16x32_bf16 v[92:95], v[76:79], v[216:219], v[92:95]
  v_pk_mov_b32 v[54:55], v[40:41], v[42:43] op_sel:[1,0]
  ds_write_b128 v11, v[44:47] offset:8320
  v_mfma_f32_16x16x32_bf16 v[96:99], v[76:79], v[220:223], v[96:99]
  ds_write_b128 v11, v[46:49] offset:24960
  s_nop 0
  v_mfma_f32_16x16x32_bf16 v[100:103], v[76:79], v[224:227], v[100:103]
  ds_read_b128 v[76:79], v9 offset:3328
  s_waitcnt lgkmcnt(15)
  v_mfma_f32_16x16x32_bf16 v[88:91], v[80:83], v[228:231], v[88:91]
  ds_write_b128 v11, v[50:53] offset:12480
  ds_write_b128 v11, v[52:55] offset:29120
  v_mfma_f32_16x16x32_bf16 v[92:95], v[80:83], v[232:235], v[92:95]
  v_mfma_f32_16x16x32_bf16 v[96:99], v[80:83], v[236:239], v[96:99]
  v_mfma_f32_16x16x32_bf16 v[100:103], v[80:83], v[240:243], v[100:103]
  ds_read_b128 v[80:83], v9 offset:3264
  s_waitcnt lgkmcnt(15)
  v_mfma_f32_16x16x32_bf16 v[88:91], v[84:87], v[244:247], v[88:91]
  v_mfma_f32_16x16x32_bf16 v[92:95], v[84:87], v[120:123], v[92:95]
  v_mfma_f32_16x16x32_bf16 v[96:99], v[84:87], v[124:127], v[96:99]
  v_mfma_f32_16x16x32_bf16 v[100:103], v[84:87], v[128:131], v[100:103]
  ds_read_b128 v[84:87], v9 offset:3200
  s_waitcnt lgkmcnt(13)
  v_mfma_f32_16x16x32_bf16 v[92:95], v[64:67], v[132:135], v[92:95]
  v_mfma_f32_16x16x32_bf16 v[96:99], v[64:67], v[136:139], v[96:99]
  v_mfma_f32_16x16x32_bf16 v[100:103], v[64:67], v[140:143], v[100:103]
  v_mfma_f32_16x16x32_bf16 v[104:107], v[64:67], v[144:147], v[104:107]
  ds_read_b128 v[64:67], v9 offset:3136
  s_waitcnt lgkmcnt(13)
  v_mfma_f32_16x16x32_bf16 v[92:95], v[68:71], v[148:151], v[92:95]
  s_waitcnt lgkmcnt(12)
  v_and_b32 v12, s40, v57
  v_mfma_f32_16x16x32_bf16 v[96:99], v[68:71], v[152:155], v[96:99]
  v_lshlrev_b32 v13, 16, v57
  v_and_b32 v14, s40, v56
  v_mfma_f32_16x16x32_bf16 v[100:103], v[68:71], v[156:159], v[100:103]
  v_lshlrev_b32 v15, 16, v56
  s_nop 0
  v_mfma_f32_16x16x32_bf16 v[104:107], v[68:71], v[160:163], v[104:107]
  ds_read_b128 v[68:71], v9 offset:3072
  s_waitcnt lgkmcnt(9)
  v_mfma_f32_16x16x32_bf16 v[92:95], v[72:75], v[164:167], v[92:95]
  s_nop 0
  v_pk_fma_f32 v[12:13], v[12:13], v[18:19], v[88:89]
  v_mfma_f32_16x16x32_bf16 v[96:99], v[72:75], v[168:171], v[96:99]
  v_pk_fma_f32 v[14:15], v[14:15], v[18:19], v[90:91]
  s_nop 0
  v_mfma_f32_16x16x32_bf16 v[100:103], v[72:75], v[172:175], v[100:103]
  v_cvt_pk_bf16_f32 v16, v12, v13
  v_cvt_pk_bf16_f32 v17, v14, v15
  v_mfma_f32_16x16x32_bf16 v[104:107], v[72:75], v[176:179], v[104:107]
  ds_read_b128 v[72:75], v9 offset:3008
  s_waitcnt lgkmcnt(7)
  v_mfma_f32_16x16x32_bf16 v[92:95], v[76:79], v[180:183], v[92:95]
  ds_write_b64 v6, v[16:17] offset:0
  v_mov_b32 v8, 1
  v_mfma_f32_16x16x32_bf16 v[96:99], v[76:79], v[184:187], v[96:99]
  v_mfma_f32_16x16x32_bf16 v[100:103], v[76:79], v[188:191], v[100:103]
  s_waitcnt lgkmcnt(0)
  v_mfma_f32_16x16x32_bf16 v[104:107], v[76:79], v[192:195], v[104:107]
  ds_read_b128 v[76:79], v9 offset:2944
  ds_read_b64 v[58:59], v7 offset:3072
  s_waitcnt lgkmcnt(7)
  v_mfma_f32_16x16x32_bf16 v[92:95], v[80:83], v[196:199], v[92:95]
  ds_write_b32 v10, v8
  v_mfma_f32_16x16x32_bf16 v[96:99], v[80:83], v[200:203], v[96:99]
  v_mfma_f32_16x16x32_bf16 v[100:103], v[80:83], v[204:207], v[100:103]
  v_mfma_f32_16x16x32_bf16 v[104:107], v[80:83], v[208:211], v[104:107]
  ds_read_b128 v[80:83], v9 offset:2880
  s_waitcnt lgkmcnt(8)
  v_mfma_f32_16x16x32_bf16 v[92:95], v[84:87], v[212:215], v[92:95]
  v_mfma_f32_16x16x32_bf16 v[96:99], v[84:87], v[216:219], v[96:99]
  v_mfma_f32_16x16x32_bf16 v[100:103], v[84:87], v[220:223], v[100:103]
  v_mfma_f32_16x16x32_bf16 v[104:107], v[84:87], v[224:227], v[104:107]
  ds_read_b128 v[84:87], v9 offset:2816
  s_waitcnt lgkmcnt(8)
  v_mfma_f32_16x16x32_bf16 v[92:95], v[64:67], v[228:231], v[92:95]
  v_mfma_f32_16x16x32_bf16 v[96:99], v[64:67], v[232:235], v[96:99]
  v_mfma_f32_16x16x32_bf16 v[100:103], v[64:67], v[236:239], v[100:103]
  v_mfma_f32_16x16x32_bf16 v[104:107], v[64:67], v[240:243], v[104:107]
  ds_read_b128 v[64:67], v9 offset:2752
  s_waitcnt lgkmcnt(8)
  v_mfma_f32_16x16x32_bf16 v[92:95], v[68:71], v[244:247], v[92:95]
  v_mfma_f32_16x16x32_bf16 v[96:99], v[68:71], v[120:123], v[96:99]
  v_mfma_f32_16x16x32_bf16 v[100:103], v[68:71], v[124:127], v[100:103]
  v_mfma_f32_16x16x32_bf16 v[104:107], v[68:71], v[128:131], v[104:107]
  ds_read_b128 v[68:71], v9 offset:2688
  s_waitcnt lgkmcnt(8)
  v_mfma_f32_16x16x32_bf16 v[96:99], v[72:75], v[132:135], v[96:99]
  v_mfma_f32_16x16x32_bf16 v[100:103], v[72:75], v[136:139], v[100:103]
  v_mfma_f32_16x16x32_bf16 v[104:107], v[72:75], v[140:143], v[104:107]
  v_mfma_f32_16x16x32_bf16 v[108:111], v[72:75], v[144:147], v[108:111]
  ds_read_b128 v[72:75], v9 offset:2624
  s_waitcnt lgkmcnt(7)
  v_mfma_f32_16x16x32_bf16 v[96:99], v[76:79], v[148:151], v[96:99]
  s_waitcnt lgkmcnt(6)
  v_and_b32 v12, s40, v59
  v_mfma_f32_16x16x32_bf16 v[100:103], v[76:79], v[152:155], v[100:103]
  v_lshlrev_b32 v13, 16, v59
  v_and_b32 v14, s40, v58
  v_mfma_f32_16x16x32_bf16 v[104:107], v[76:79], v[156:159], v[104:107]
  v_lshlrev_b32 v15, 16, v58
  s_nop 0
  v_mfma_f32_16x16x32_bf16 v[108:111], v[76:79], v[160:163], v[108:111]
  ds_read_b128 v[76:79], v9 offset:2560
  s_waitcnt lgkmcnt(5)
  v_mfma_f32_16x16x32_bf16 v[96:99], v[80:83], v[164:167], v[96:99]
  s_nop 0
  v_pk_fma_f32 v[12:13], v[12:13], v[18:19], v[92:93]
  v_mfma_f32_16x16x32_bf16 v[100:103], v[80:83], v[168:171], v[100:103]
  v_pk_fma_f32 v[14:15], v[14:15], v[18:19], v[94:95]
  s_nop 0
  v_mfma_f32_16x16x32_bf16 v[104:107], v[80:83], v[172:175], v[104:107]
  v_cvt_pk_bf16_f32 v16, v12, v13
  v_cvt_pk_bf16_f32 v17, v14, v15
  v_mfma_f32_16x16x32_bf16 v[108:111], v[80:83], v[176:179], v[108:111]
  ds_read_b128 v[80:83], v9 offset:2496
  s_waitcnt lgkmcnt(5)
  v_mfma_f32_16x16x32_bf16 v[96:99], v[84:87], v[180:183], v[96:99]
  ds_write_b64 v6, v[16:17] offset:512
  v_mov_b32 v8, 2
  v_mfma_f32_16x16x32_bf16 v[100:103], v[84:87], v[184:187], v[100:103]
  v_mfma_f32_16x16x32_bf16 v[104:107], v[84:87], v[188:191], v[104:107]
  s_waitcnt lgkmcnt(0)
  v_mfma_f32_16x16x32_bf16 v[108:111], v[84:87], v[192:195], v[108:111]
  ds_read_b128 v[84:87], v9 offset:2432
  ds_read_b64 v[56:57], v7 offset:2560
  s_waitcnt lgkmcnt(7)
  v_mfma_f32_16x16x32_bf16 v[96:99], v[64:67], v[196:199], v[96:99]
  ds_write_b32 v10, v8
  v_mfma_f32_16x16x32_bf16 v[100:103], v[64:67], v[200:203], v[100:103]
  v_mfma_f32_16x16x32_bf16 v[104:107], v[64:67], v[204:207], v[104:107]
  v_mfma_f32_16x16x32_bf16 v[108:111], v[64:67], v[208:211], v[108:111]
  ds_read_b128 v[64:67], v9 offset:2368
  s_waitcnt lgkmcnt(8)
  v_mfma_f32_16x16x32_bf16 v[96:99], v[68:71], v[212:215], v[96:99]
  v_mfma_f32_16x16x32_bf16 v[100:103], v[68:71], v[216:219], v[100:103]
  v_mfma_f32_16x16x32_bf16 v[104:107], v[68:71], v[220:223], v[104:107]
  v_mfma_f32_16x16x32_bf16 v[108:111], v[68:71], v[224:227], v[108:111]
  ds_read_b128 v[68:71], v9 offset:2304
  s_waitcnt lgkmcnt(8)
  v_mfma_f32_16x16x32_bf16 v[96:99], v[72:75], v[228:231], v[96:99]
  v_mfma_f32_16x16x32_bf16 v[100:103], v[72:75], v[232:235], v[100:103]
  v_mfma_f32_16x16x32_bf16 v[104:107], v[72:75], v[236:239], v[104:107]
  v_mfma_f32_16x16x32_bf16 v[108:111], v[72:75], v[240:243], v[108:111]
  ds_read_b128 v[72:75], v9 offset:2240
  s_waitcnt lgkmcnt(8)
  v_mfma_f32_16x16x32_bf16 v[96:99], v[76:79], v[244:247], v[96:99]
  v_mfma_f32_16x16x32_bf16 v[100:103], v[76:79], v[120:123], v[100:103]
  v_mfma_f32_16x16x32_bf16 v[104:107], v[76:79], v[124:127], v[104:107]
  v_mfma_f32_16x16x32_bf16 v[108:111], v[76:79], v[128:131], v[108:111]
  ds_read_b128 v[76:79], v9 offset:2176
  s_waitcnt lgkmcnt(8)
  v_mfma_f32_16x16x32_bf16 v[100:103], v[80:83], v[132:135], v[100:103]
  v_mfma_f32_16x16x32_bf16 v[104:107], v[80:83], v[136:139], v[104:107]
  v_mfma_f32_16x16x32_bf16 v[108:111], v[80:83], v[140:143], v[108:111]
  v_mfma_f32_16x16x32_bf16 v[112:115], v[80:83], v[144:147], v[112:115]
  ds_read_b128 v[80:83], v9 offset:2112
  s_waitcnt lgkmcnt(7)
  v_mfma_f32_16x16x32_bf16 v[100:103], v[84:87], v[148:151], v[100:103]
  s_waitcnt lgkmcnt(6)
  v_and_b32 v12, s40, v57
  v_mfma_f32_16x16x32_bf16 v[104:107], v[84:87], v[152:155], v[104:107]
  v_lshlrev_b32 v13, 16, v57
  v_and_b32 v14, s40, v56
  v_mfma_f32_16x16x32_bf16 v[108:111], v[84:87], v[156:159], v[108:111]
  v_lshlrev_b32 v15, 16, v56
  s_nop 0
  v_mfma_f32_16x16x32_bf16 v[112:115], v[84:87], v[160:163], v[112:115]
  ds_read_b128 v[84:87], v9 offset:2048
  s_waitcnt lgkmcnt(5)
  v_mfma_f32_16x16x32_bf16 v[100:103], v[64:67], v[164:167], v[100:103]
  s_nop 0
  v_pk_fma_f32 v[12:13], v[12:13], v[18:19], v[96:97]
  v_mfma_f32_16x16x32_bf16 v[104:107], v[64:67], v[168:171], v[104:107]
  v_pk_fma_f32 v[14:15], v[14:15], v[18:19], v[98:99]
  s_nop 0
  v_mfma_f32_16x16x32_bf16 v[108:111], v[64:67], v[172:175], v[108:111]
  v_cvt_pk_bf16_f32 v16, v12, v13
  v_cvt_pk_bf16_f32 v17, v14, v15
  v_mfma_f32_16x16x32_bf16 v[112:115], v[64:67], v[176:179], v[112:115]
  ds_read_b128 v[64:67], v9 offset:1984
  s_waitcnt lgkmcnt(5)
  v_mfma_f32_16x16x32_bf16 v[100:103], v[68:71], v[180:183], v[100:103]
  ds_write_b64 v6, v[16:17] offset:1024
  v_mov_b32 v8, 3
  v_mfma_f32_16x16x32_bf16 v[104:107], v[68:71], v[184:187], v[104:107]
  v_mfma_f32_16x16x32_bf16 v[108:111], v[68:71], v[188:191], v[108:111]
  s_waitcnt lgkmcnt(0)
  v_mfma_f32_16x16x32_bf16 v[112:115], v[68:71], v[192:195], v[112:115]
  ds_read_b128 v[68:71], v9 offset:1920
  ds_read_b64 v[58:59], v7 offset:2048
  s_waitcnt lgkmcnt(7)
  v_mfma_f32_16x16x32_bf16 v[100:103], v[72:75], v[196:199], v[100:103]
  ds_write_b32 v10, v8
  v_mfma_f32_16x16x32_bf16 v[104:107], v[72:75], v[200:203], v[104:107]
  v_mfma_f32_16x16x32_bf16 v[108:111], v[72:75], v[204:207], v[108:111]
  v_mfma_f32_16x16x32_bf16 v[112:115], v[72:75], v[208:211], v[112:115]
  ds_read_b128 v[72:75], v9 offset:1856
  s_waitcnt lgkmcnt(8)
  v_mfma_f32_16x16x32_bf16 v[100:103], v[76:79], v[212:215], v[100:103]
  v_mfma_f32_16x16x32_bf16 v[104:107], v[76:79], v[216:219], v[104:107]
  v_mfma_f32_16x16x32_bf16 v[108:111], v[76:79], v[220:223], v[108:111]
  v_mfma_f32_16x16x32_bf16 v[112:115], v[76:79], v[224:227], v[112:115]
  ds_read_b128 v[76:79], v9 offset:1792
  s_waitcnt lgkmcnt(8)
  v_mfma_f32_16x16x32_bf16 v[100:103], v[80:83], v[228:231], v[100:103]
  v_mfma_f32_16x16x32_bf16 v[104:107], v[80:83], v[232:235], v[104:107]
  v_mfma_f32_16x16x32_bf16 v[108:111], v[80:83], v[236:239], v[108:111]
  v_mfma_f32_16x16x32_bf16 v[112:115], v[80:83], v[240:243], v[112:115]
  ds_read_b128 v[80:83], v9 offset:1728
  s_waitcnt lgkmcnt(8)
  v_mfma_f32_16x16x32_bf16 v[100:103], v[84:87], v[244:247], v[100:103]
  v_mfma_f32_16x16x32_bf16 v[104:107], v[84:87], v[120:123], v[104:107]
  v_mfma_f32_16x16x32_bf16 v[108:111], v[84:87], v[124:127], v[108:111]
  v_mfma_f32_16x16x32_bf16 v[112:115], v[84:87], v[128:131], v[112:115]
  ds_read_b128 v[84:87], v9 offset:1664
  s_waitcnt lgkmcnt(8)
  v_mfma_f32_16x16x32_bf16 v[104:107], v[64:67], v[132:135], v[104:107]
  v_mfma_f32_16x16x32_bf16 v[108:111], v[64:67], v[136:139], v[108:111]
  v_mfma_f32_16x16x32_bf16 v[112:115], v[64:67], v[140:143], v[112:115]
  v_mfma_f32_16x16x32_bf16 v[116:119], v[64:67], v[144:147], v[116:119]
  ds_read_b128 v[64:67], v9 offset:1600
  s_waitcnt lgkmcnt(7)
  v_mfma_f32_16x16x32_bf16 v[104:107], v[68:71], v[148:151], v[104:107]
  s_waitcnt lgkmcnt(6)
  v_and_b32 v12, s40, v59
  v_mfma_f32_16x16x32_bf16 v[108:111], v[68:71], v[152:155], v[108:111]
  v_lshlrev_b32 v13, 16, v59
  v_and_b32 v14, s40, v58
  v_mfma_f32_16x16x32_bf16 v[112:115], v[68:71], v[156:159], v[112:115]
  v_lshlrev_b32 v15, 16, v58
  s_nop 0
  v_mfma_f32_16x16x32_bf16 v[116:119], v[68:71], v[160:163], v[116:119]
  ds_read_b128 v[68:71], v9 offset:1536
  s_waitcnt lgkmcnt(5)
  v_mfma_f32_16x16x32_bf16 v[104:107], v[72:75], v[164:167], v[104:107]
  s_nop 0
  v_pk_fma_f32 v[12:13], v[12:13], v[18:19], v[100:101]
  v_mfma_f32_16x16x32_bf16 v[108:111], v[72:75], v[168:171], v[108:111]
  v_pk_fma_f32 v[14:15], v[14:15], v[18:19], v[102:103]
  s_nop 0
  v_mfma_f32_16x16x32_bf16 v[112:115], v[72:75], v[172:175], v[112:115]
  v_cvt_pk_bf16_f32 v16, v12, v13
  v_cvt_pk_bf16_f32 v17, v14, v15
  v_mfma_f32_16x16x32_bf16 v[116:119], v[72:75], v[176:179], v[116:119]
  ds_read_b128 v[72:75], v9 offset:1472
  s_waitcnt lgkmcnt(5)
  v_mfma_f32_16x16x32_bf16 v[104:107], v[76:79], v[180:183], v[104:107]
  ds_write_b64 v6, v[16:17] offset:1536
  v_mov_b32 v8, 4
  v_mfma_f32_16x16x32_bf16 v[108:111], v[76:79], v[184:187], v[108:111]
  v_mfma_f32_16x16x32_bf16 v[112:115], v[76:79], v[188:191], v[112:115]
  s_waitcnt lgkmcnt(0)
  v_mfma_f32_16x16x32_bf16 v[116:119], v[76:79], v[192:195], v[116:119]
  ds_read_b128 v[76:79], v9 offset:1408
  ds_read_b64 v[56:57], v7 offset:1536
  s_waitcnt lgkmcnt(7)
  v_mfma_f32_16x16x32_bf16 v[104:107], v[80:83], v[196:199], v[104:107]
  ds_write_b32 v10, v8
  v_mfma_f32_16x16x32_bf16 v[108:111], v[80:83], v[200:203], v[108:111]
  v_mfma_f32_16x16x32_bf16 v[112:115], v[80:83], v[204:207], v[112:115]
  v_mfma_f32_16x16x32_bf16 v[116:119], v[80:83], v[208:211], v[116:119]
  ds_read_b128 v[80:83], v9 offset:1344
  s_waitcnt lgkmcnt(8)
  v_mfma_f32_16x16x32_bf16 v[104:107], v[84:87], v[212:215], v[104:107]
  v_mfma_f32_16x16x32_bf16 v[108:111], v[84:87], v[216:219], v[108:111]
  v_mfma_f32_16x16x32_bf16 v[112:115], v[84:87], v[220:223], v[112:115]
  v_mfma_f32_16x16x32_bf16 v[116:119], v[84:87], v[224:227], v[116:119]
  ds_read_b128 v[84:87], v9 offset:1280
  s_waitcnt lgkmcnt(8)
  v_mfma_f32_16x16x32_bf16 v[104:107], v[64:67], v[228:231], v[104:107]
  v_mfma_f32_16x16x32_bf16 v[108:111], v[64:67], v[232:235], v[108:111]
  v_mfma_f32_16x16x32_bf16 v[112:115], v[64:67], v[236:239], v[112:115]
  v_mfma_f32_16x16x32_bf16 v[116:119], v[64:67], v[240:243], v[116:119]
  ds_read_b128 v[64:67], v9 offset:1216
  s_waitcnt lgkmcnt(8)
  v_mfma_f32_16x16x32_bf16 v[104:107], v[68:71], v[244:247], v[104:107]
  v_mfma_f32_16x16x32_bf16 v[108:111], v[68:71], v[120:123], v[108:111]
  v_mfma_f32_16x16x32_bf16 v[112:115], v[68:71], v[124:127], v[112:115]
  v_mfma_f32_16x16x32_bf16 v[116:119], v[68:71], v[128:131], v[116:119]
  ds_read_b128 v[68:71], v9 offset:1152
  s_waitcnt lgkmcnt(8)
  v_mfma_f32_16x16x32_bf16 v[108:111], v[72:75], v[132:135], v[108:111]
  v_mfma_f32_16x16x32_bf16 v[112:115], v[72:75], v[136:139], v[112:115]
  v_mfma_f32_16x16x32_bf16 v[116:119], v[72:75], v[140:143], v[116:119]
  ds_read_b128 v[72:75], v9 offset:1088
  s_waitcnt lgkmcnt(7)
  v_mfma_f32_16x16x32_bf16 v[108:111], v[76:79], v[148:151], v[108:111]
  s_waitcnt lgkmcnt(6)
  v_and_b32 v12, s40, v57
  v_mfma_f32_16x16x32_bf16 v[112:115], v[76:79], v[152:155], v[112:115]
  v_lshlrev_b32 v13, 16, v57
  v_and_b32 v14, s40, v56
  v_mfma_f32_16x16x32_bf16 v[116:119], v[76:79], v[156:159], v[116:119]
  ds_read_b128 v[76:79], v9 offset:1024
  s_waitcnt lgkmcnt(5)
  v_mfma_f32_16x16x32_bf16 v[108:111], v[80:83], v[164:167], v[108:111]
  v_lshlrev_b32 v15, 16, v56
  s_nop 0
  v_mfma_f32_16x16x32_bf16 v[112:115], v[80:83], v[168:171], v[112:115]
  s_nop 0
  v_pk_fma_f32 v[12:13], v[12:13], v[18:19], v[104:105]
  v_mfma_f32_16x16x32_bf16 v[116:119], v[80:83], v[172:175], v[116:119]
  ds_read_b128 v[80:83], v9 offset:960
  s_waitcnt lgkmcnt(5)
  v_mfma_f32_16x16x32_bf16 v[108:111], v[84:87], v[180:183], v[108:111]
  v_pk_fma_f32 v[14:15], v[14:15], v[18:19], v[106:107]
  s_nop 0
  v_mfma_f32_16x16x32_bf16 v[112:115], v[84:87], v[184:187], v[112:115]
  v_cvt_pk_bf16_f32 v16, v12, v13
  v_cvt_pk_bf16_f32 v17, v14, v15
  v_mfma_f32_16x16x32_bf16 v[116:119], v[84:87], v[188:191], v[116:119]
  ds_read_b128 v[84:87], v9 offset:896
  ds_read_b64 v[58:59], v7 offset:1024
  s_waitcnt lgkmcnt(6)
  v_mfma_f32_16x16x32_bf16 v[108:111], v[64:67], v[196:199], v[108:111]
  ds_write_b64 v6, v[16:17] offset:2048
  v_mov_b32 v8, 5
  v_mfma_f32_16x16x32_bf16 v[112:115], v[64:67], v[200:203], v[112:115]
  v_mfma_f32_16x16x32_bf16 v[116:119], v[64:67], v[204:207], v[116:119]
  ds_read_b128 v[64:67], v9 offset:832
  s_waitcnt lgkmcnt(7)
  v_mfma_f32_16x16x32_bf16 v[108:111], v[68:71], v[212:215], v[108:111]
  s_waitcnt lgkmcnt(1)
  v_mfma_f32_16x16x32_bf16 v[112:115], v[68:71], v[216:219], v[112:115]
  ds_write_b32 v10, v8
  v_mfma_f32_16x16x32_bf16 v[116:119], v[68:71], v[220:223], v[116:119]
  ds_read_b128 v[68:71], v9 offset:768
  s_waitcnt lgkmcnt(8)
  v_mfma_f32_16x16x32_bf16 v[108:111], v[72:75], v[228:231], v[108:111]
  v_mfma_f32_16x16x32_bf16 v[112:115], v[72:75], v[232:235], v[112:115]
  v_mfma_f32_16x16x32_bf16 v[116:119], v[72:75], v[236:239], v[116:119]
  ds_read_b128 v[72:75], v9 offset:704
  s_waitcnt lgkmcnt(8)
  v_mfma_f32_16x16x32_bf16 v[108:111], v[76:79], v[244:247], v[108:111]
  v_mfma_f32_16x16x32_bf16 v[112:115], v[76:79], v[120:123], v[112:115]
  v_mfma_f32_16x16x32_bf16 v[116:119], v[76:79], v[124:127], v[116:119]
  ds_read_b128 v[76:79], v9 offset:640
  s_waitcnt lgkmcnt(8)
  v_mfma_f32_16x16x32_bf16 v[112:115], v[80:83], v[132:135], v[112:115]
  v_mfma_f32_16x16x32_bf16 v[116:119], v[80:83], v[136:139], v[116:119]
  ds_read_b128 v[80:83], v9 offset:576
  s_waitcnt lgkmcnt(8)
  v_mfma_f32_16x16x32_bf16 v[112:115], v[84:87], v[148:151], v[112:115]
  s_waitcnt lgkmcnt(7)
  v_and_b32 v12, s40, v59
  v_mfma_f32_16x16x32_bf16 v[116:119], v[84:87], v[152:155], v[116:119]
  ds_read_b128 v[84:87], v9 offset:512
  s_waitcnt lgkmcnt(6)
  v_mfma_f32_16x16x32_bf16 v[112:115], v[64:67], v[164:167], v[112:115]
  v_lshlrev_b32 v13, 16, v59
  v_and_b32 v14, s40, v58
  v_mfma_f32_16x16x32_bf16 v[116:119], v[64:67], v[168:171], v[116:119]
  ds_read_b128 v[64:67], v9 offset:448
  s_waitcnt lgkmcnt(5)
  v_mfma_f32_16x16x32_bf16 v[112:115], v[68:71], v[180:183], v[112:115]
  v_lshlrev_b32 v15, 16, v58
  s_nop 0
  v_mfma_f32_16x16x32_bf16 v[116:119], v[68:71], v[184:187], v[116:119]
  ds_read_b128 v[68:71], v9 offset:384
  ds_read_b64 v[56:57], v7 offset:512
  s_waitcnt lgkmcnt(6)
  v_mfma_f32_16x16x32_bf16 v[112:115], v[72:75], v[196:199], v[112:115]
  s_nop 0
  v_pk_fma_f32 v[12:13], v[12:13], v[18:19], v[108:109]
  v_mfma_f32_16x16x32_bf16 v[116:119], v[72:75], v[200:203], v[116:119]
  ds_read_b128 v[72:75], v9 offset:320
  s_waitcnt lgkmcnt(6)
  v_mfma_f32_16x16x32_bf16 v[112:115], v[76:79], v[212:215], v[112:115]
  v_pk_fma_f32 v[14:15], v[14:15], v[18:19], v[110:111]
  s_nop 0
  v_mfma_f32_16x16x32_bf16 v[116:119], v[76:79], v[216:219], v[116:119]
  ds_read_b128 v[76:79], v9 offset:256
  s_waitcnt lgkmcnt(6)
  v_mfma_f32_16x16x32_bf16 v[112:115], v[80:83], v[228:231], v[112:115]
  v_cvt_pk_bf16_f32 v16, v12, v13
  v_cvt_pk_bf16_f32 v17, v14, v15
  v_mfma_f32_16x16x32_bf16 v[116:119], v[80:83], v[232:235], v[116:119]
  ds_read_b128 v[80:83], v9 offset:192
  s_waitcnt lgkmcnt(6)
  v_mfma_f32_16x16x32_bf16 v[112:115], v[84:87], v[244:247], v[112:115]
  ds_write_b64 v6, v[16:17] offset:2560
  v_mov_b32 v8, 6
  v_mfma_f32_16x16x32_bf16 v[116:119], v[84:87], v[120:123], v[116:119]
  ds_read_b128 v[84:87], v9 offset:128
  s_waitcnt lgkmcnt(7)
  v_mfma_f32_16x16x32_bf16 v[116:119], v[64:67], v[132:135], v[116:119]
  ds_read_b128 v[64:67], v9 offset:64
  s_waitcnt lgkmcnt(7)
  v_mfma_f32_16x16x32_bf16 v[116:119], v[68:71], v[148:151], v[116:119]
  ds_read_b128 v[68:71], v9 offset:0
  s_waitcnt lgkmcnt(6)
  v_mfma_f32_16x16x32_bf16 v[116:119], v[72:75], v[164:167], v[116:119]
  s_waitcnt lgkmcnt(5)
  v_mfma_f32_16x16x32_bf16 v[116:119], v[76:79], v[180:183], v[116:119]
  s_waitcnt lgkmcnt(3)
  ds_read_b64 v[58:59], v7 offset:0
  s_waitcnt lgkmcnt(5)
  v_mfma_f32_16x16x32_bf16 v[116:119], v[80:83], v[196:199], v[116:119]
  ds_write_b32 v10, v8
  s_waitcnt lgkmcnt(4)
  v_mfma_f32_16x16x32_bf16 v[116:119], v[84:87], v[212:215], v[116:119]
  s_waitcnt lgkmcnt(9)
  s_waitcnt lgkmcnt(3)
  v_mfma_f32_16x16x32_bf16 v[116:119], v[64:67], v[228:231], v[116:119]
  v_and_b32 v12, s40, v57
  s_waitcnt lgkmcnt(2)
  v_mfma_f32_16x16x32_bf16 v[116:119], v[68:71], v[244:247], v[116:119]
  v_lshlrev_b32 v13, 16, v57
  s_nop 3
  v_and_b32 v14, s40, v56
  v_lshlrev_b32 v15, 16, v56
  s_nop 0
  s_nop 0
  v_pk_fma_f32 v[12:13], v[12:13], v[18:19], v[112:113]
  v_pk_fma_f32 v[14:15], v[14:15], v[18:19], v[114:115]
  s_nop 0
  v_cvt_pk_bf16_f32 v16, v12, v13
  v_cvt_pk_bf16_f32 v17, v14, v15
  ds_write_b64 v6, v[16:17] offset:3072
  v_mov_b32 v8, 7
  s_waitcnt lgkmcnt(0)
  ds_write_b32 v10, v8
  s_waitcnt lgkmcnt(3)
  v_and_b32 v12, s40, v59
  v_lshlrev_b32 v13, 16, v59
  v_and_b32 v14, s40, v58
  v_lshlrev_b32 v15, 16, v58
  s_nop 0
  s_nop 0
  v_pk_fma_f32 v[12:13], v[12:13], v[18:19], v[116:117]
  v_pk_fma_f32 v[14:15], v[14:15], v[18:19], v[118:119]
  s_nop 0
  v_cvt_pk_bf16_f32 v16, v12, v13
  v_cvt_pk_bf16_f32 v17, v14, v15
  ds_write_b64 v6, v[16:17] offset:3584
  v_mov_b32 v8, 8
  s_waitcnt lgkmcnt(0)
  ds_write_b32 v10, v8
  v_and_b32 v5, 255, v0
  v_and_b32 v1, 63, v0
  v_and_b32 v12, 7, v5
  v_mul_u32_u24 v12, 2304, v12
  v_lshrrev_b32 v13, 3, v5
  v_mul_u32_u24 v14, 18432, v13
  v_add_u32 v12, v12, v14
  s_lshl_b32 s51, s41, 4
  s_add_u32 s51, s51, 5242880
  v_add_u32 v12, s51, v12
  v_add_u32 v14, 1179648, v12
  v_cmp_gt_u32 vcc, 8, v13
  s_nop 1
  v_cndmask_b32 v14, v12, v14, vcc
  s_mov_b64 s[56:57], vcc
  s_mov_b32 s52, 0
L_ppp_52:
  s_mov_b32 s51, 589824
  buffer_load_dwordx4 v[160:163], v12, s[36:39], 0 offen sc1
  buffer_load_dwordx4 v[164:167], v12, s[36:39], s51 offen sc1
  buffer_load_dwordx4 v[168:171], v14, s[36:39], 0 offen sc1
  s_waitcnt vmcnt(0)
  v_xor_b32 v172, v160, v161
  v_xor_b32 v176, v162, v163
  v_xor_b32 v173, v164, v165
  v_xor_b32 v177, v166, v167
  v_xor_b32 v174, v168, v169
  v_xor_b32 v178, v170, v171
  v_xor_b32 v172, v172, v176
  v_xor_b32 v173, v173, v177
  v_xor_b32 v174, v174, v178
  v_cmp_eq_u32 vcc, s46, v172
  v_cmp_eq_u32 s[54:55], s46, v173
  s_and_b64 vcc, vcc, s[54:55]
  v_cmp_eq_u32 s[54:55], s46, v174
  s_and_b64 vcc, vcc, s[54:55]
  s_andn2_b64 exec, exec, vcc
  s_cbranch_scc0 L_ppok_53
  s_add_u32 s52, s52, 1
  s_cmp_gt_u32 s52, 200000
  s_cbranch_scc1 L_ppok_53
  s_sleep 6
  s_branch L_ppp_52
L_ppok_53:
  s_mov_b64 exec, -1
  s_mov_b32 s58, 0xffffff00
  s_mov_b32 s59, 0x0c0c0004
  v_lshlrev_b32 v23, 24, v160
  v_and_b32 v176, 0xff, v161
  v_and_b32 v177, 0xff, v162
  v_lshl_or_b32 v23, v176, 16, v23
  v_lshl_or_b32 v23, v177, 8, v23
  v_and_b32 v20, s58, v160
  v_and_b32 v21, s58, v161
  v_and_b32 v22, s58, v162
  v_lshlrev_b32 v27, 24, v164
  v_and_b32 v176, 0xff, v165
  v_and_b32 v177, 0xff, v166
  v_lshl_or_b32 v27, v176, 16, v27
  v_lshl_or_b32 v27, v177, 8, v27
  v_and_b32 v24, s58, v164
  v_and_b32 v25, s58, v165
  v_and_b32 v26, s58, v166
  v_lshlrev_b32 v31, 24, v168
  v_and_b32 v176, 0xff, v169
  v_and_b32 v177, 0xff, v170
  v_lshl_or_b32 v31, v176, 16, v31
  v_lshl_or_b32 v31, v177, 8, v31
  v_and_b32 v28, s58, v168
  v_and_b32 v29, s58, v169
  v_and_b32 v30, s58, v170
  v_cndmask_b32 v28, 0, v28, s[56:57]
  v_cndmask_b32 v29, 0, v29, s[56:57]
  v_cndmask_b32 v30, 0, v30, s[56:57]
  v_cndmask_b32 v31, 0, v31, s[56:57]
  v_add_f32 v20, v20, v24
  v_add_f32 v21, v21, v25
  v_add_f32 v22, v22, v26
  v_add_f32 v23, v23, v27
  v_add_f32 v20, v20, v28
  v_add_f32 v21, v21, v29
  v_add_f32 v22, v22, v30
  v_add_f32 v23, v23, v31
  s_nop 0
  v_add_f32_dpp v24, v20, v20 row_ror:8 row_mask:0xf bank_mask:0xf
  v_add_f32_dpp v25, v21, v21 row_ror:8 row_mask:0xf bank_mask:0xf
  v_add_f32_dpp v26, v22, v22 row_ror:8 row_mask:0xf bank_mask:0xf
  v_add_f32_dpp v27, v23, v23 row_ror:8 row_mask:0xf bank_mask:0xf
  v_mov_b32 v28, v24
  v_mov_b32 v29, v25
  v_mov_b32 v30, v26
  v_mov_b32 v31, v27
  s_nop 0
  v_permlane16_swap_b32 v24, v28
  v_permlane16_swap_b32 v25, v29
  v_permlane16_swap_b32 v26, v30
  v_permlane16_swap_b32 v27, v31
  s_nop 0
  v_add_f32 v24, v24, v28
  v_add_f32 v25, v25, v29
  v_add_f32 v26, v26, v30
  v_add_f32 v27, v27, v31
  v_mov_b32 v28, v24
  v_mov_b32 v29, v25
  v_mov_b32 v30, v26
  v_mov_b32 v31, v27
  s_nop 0
  v_permlane32_swap_b32 v24, v28
  v_permlane32_swap_b32 v25, v29
  v_permlane32_swap_b32 v26, v30
  v_permlane32_swap_b32 v27, v31
  s_nop 0
  v_add_f32 v24, v24, v28
  v_add_f32 v25, v25, v29
  v_add_f32 v26, v26, v30
  v_add_f32 v27, v27, v31
  v_lshlrev_b32 v18, 4, v1
  s_lshl_b32 s51, s43, 7
  s_add_u32 s51, s51, 152128
  v_add_u32 v18, s51, v18
  s_mov_b64 exec, 0xff
  ds_write_b128 v18, v[24:27]
  s_mov_b64 exec, -1
  s_waitcnt lgkmcnt(0)
  v_mov_b32 v11, 151808
  v_mov_b32 v12, 1
  s_mov_b64 exec, 1
  ds_add_u32 v11, v12 offset:20
  s_mov_b64 exec, -1
  s_endpgm
L_moe_2:
  s_mul_i32 s31, s30, 9
  s_add_u32 s41, s41, s31
  v_and_b32 v1, 63, v0
  v_and_b32 v4, 255, v0
  v_mov_b32 v8, 162368
  v_mov_b32 v9, 1
  s_cmp_ge_u32 s42, 4
  s_cbranch_scc1 L_twave_54
  v_mov_b32 v232, 0
  v_mov_b32 v233, 0
  v_mov_b32 v234, 0
  v_mov_b32 v235, 0
  ds_write_b128 v8, v[232:235]
  ds_write_b128 v8, v[232:235] offset:16
  s_mov_b32 s48, s88
  s_and_b32 s49, s89, 0xffff
  s_mov_b32 s50, 0x510000
  s_mov_b32 s51, 0x00020000
  s_mov_b32 s52, s90
  s_and_b32 s53, s91, 0xffff
  s_mov_b32 s54, 0x510000
  s_mov_b32 s55, 0x00020000
  s_mov_b32 s56, s92
  s_and_b32 s57, s93, 0xffff
  s_mov_b32 s58, 0x510000
  s_mov_b32 s59, 0x00020000
  v_lshrrev_b32 v5, 3, v1
  v_mul_u32_u24 v5, 9216, v5
  v_bfe_u32 v6, v1, 4, 1
  s_and_b32 s43, s42, 1
  s_lshl_b32 s43, s43, 1
  v_or_b32 v6, s43, v6
  v_lshlrev_b32 v6, 1, v6
  v_and_b32 v7, 7, v1
  v_xor_b32 v6, v6, v7
  v_lshl_add_u32 v5, v6, 4, v5
  s_lshl_b32 s43, s41, 7
  s_mul_i32 s44, s42, 73728
  s_add_u32 s43, s43, s44
  s_lshl_b32 s44, s42, 10
  s_waitcnt lgkmcnt(0)
  s_barrier
  s_mov_b32 m0, s44
  s_add_u32 s45, s44, 73728
  buffer_load_dwordx4 v5, s[48:51], s43 offen nt lds
  s_mov_b32 m0, s45
  s_add_u32 s44, s44, 4096
  buffer_load_dwordx4 v5, s[52:55], s43 offen nt lds
  s_add_u32 s43, s43, 294912
  s_mov_b32 m0, s44
  s_add_u32 s45, s44, 73728
  buffer_load_dwordx4 v5, s[48:51], s43 offen nt lds
  s_mov_b32 m0, s45
  s_add_u32 s44, s44, 4096
  buffer_load_dwordx4 v5, s[52:55], s43 offen nt lds
  s_add_u32 s43, s43, 294912
  s_mov_b32 m0, s44
  s_add_u32 s45, s44, 73728
  buffer_load_dwordx4 v5, s[48:51], s43 offen nt lds
  s_mov_b32 m0, s45
  s_add_u32 s44, s44, 4096
  buffer_load_dwordx4 v5, s[52:55], s43 offen nt lds
  s_add_u32 s43, s43, 294912
  s_mov_b32 m0, s44
  s_add_u32 s45, s44, 73728
  buffer_load_dwordx4 v5, s[48:51], s43 offen nt lds
  s_mov_b32 m0, s45
  s_add_u32 s44, s44, 4096
  buffer_load_dwordx4 v5, s[52:55], s43 offen nt lds
  s_add_u32 s43, s43, 294912
  s_mov_b32 m0, s44
  s_add_u32 s45, s44, 73728
  buffer_load_dwordx4 v5, s[48:51], s43 offen nt lds
  s_mov_b32 m0, s45
  s_add_u32 s44, s44, 4096
  buffer_load_dwordx4 v5, s[52:55], s43 offen nt lds
  s_add_u32 s43, s43, 294912
  s_mov_b32 m0, s44
  s_add_u32 s45, s44, 73728
  buffer_load_dwordx4 v5, s[48:51], s43 offen nt lds
  s_mov_b32 m0, s45
  s_add_u32 s44, s44, 4096
  buffer_load_dwordx4 v5, s[52:55], s43 offen nt lds
  s_add_u32 s43, s43, 294912
  s_mov_b32 m0, s44
  s_add_u32 s45, s44, 73728
  buffer_load_dwordx4 v5, s[48:51], s43 offen nt lds
  s_mov_b32 m0, s45
  s_add_u32 s44, s44, 4096
  buffer_load_dwordx4 v5, s[52:55], s43 offen nt lds
  s_add_u32 s43, s43, 294912
  s_mov_b32 m0, s44
  s_add_u32 s45, s44, 73728
  buffer_load_dwordx4 v5, s[48:51], s43 offen nt lds
  s_mov_b32 m0, s45
  s_add_u32 s44, s44, 4096
  buffer_load_dwordx4 v5, s[52:55], s43 offen nt lds
  s_add_u32 s43, s43, 294912
  s_mov_b32 m0, s44
  s_add_u32 s45, s44, 73728
  buffer_load_dwordx4 v5, s[48:51], s43 offen nt lds
  s_mov_b32 m0, s45
  s_add_u32 s44, s44, 4096
  buffer_load_dwordx4 v5, s[52:55], s43 offen nt lds
  s_add_u32 s43, s43, 294912
  s_mov_b32 m0, s44
  s_add_u32 s45, s44, 73728
  buffer_load_dwordx4 v5, s[48:51], s43 offen nt lds
  s_mov_b32 m0, s45
  s_add_u32 s44, s44, 4096
  buffer_load_dwordx4 v5, s[52:55], s43 offen nt lds
  s_add_u32 s43, s43, 294912
  s_mov_b32 m0, s44
  s_add_u32 s45, s44, 73728
  buffer_load_dwordx4 v5, s[48:51], s43 offen nt lds
  s_mov_b32 m0, s45
  s_add_u32 s44, s44, 4096
  buffer_load_dwordx4 v5, s[52:55], s43 offen nt lds
  s_add_u32 s43, s43, 294912
  s_mov_b32 m0, s44
  s_add_u32 s45, s44, 73728
  buffer_load_dwordx4 v5, s[48:51], s43 offen nt lds
  s_mov_b32 m0, s45
  s_add_u32 s44, s44, 4096
  buffer_load_dwordx4 v5, s[52:55], s43 offen nt lds
  s_add_u32 s43, s43, 294912
  s_mov_b32 m0, s44
  s_add_u32 s45, s44, 73728
  buffer_load_dwordx4 v5, s[48:51], s43 offen nt lds
  s_mov_b32 m0, s45
  s_add_u32 s44, s44, 4096
  buffer_load_dwordx4 v5, s[52:55], s43 offen nt lds
  s_add_u32 s43, s43, 294912
  s_mov_b32 m0, s44
  s_add_u32 s45, s44, 73728
  buffer_load_dwordx4 v5, s[48:51], s43 offen nt lds
  s_mov_b32 m0, s45
  s_add_u32 s44, s44, 4096
  buffer_load_dwordx4 v5, s[52:55], s43 offen nt lds
  s_add_u32 s43, s43, 294912
  s_mov_b32 m0, s44
  s_add_u32 s45, s44, 73728
  buffer_load_dwordx4 v5, s[48:51], s43 offen nt lds
  s_mov_b32 m0, s45
  s_add_u32 s44, s44, 4096
  buffer_load_dwordx4 v5, s[52:55], s43 offen nt lds
  s_add_u32 s43, s43, 294912
  s_mov_b32 m0, s44
  s_add_u32 s45, s44, 73728
  buffer_load_dwordx4 v5, s[48:51], s43 offen nt lds
  s_mov_b32 m0, s45
  s_add_u32 s44, s44, 4096
  buffer_load_dwordx4 v5, s[52:55], s43 offen nt lds
  s_add_u32 s43, s43, 294912
  s_mov_b32 m0, s44
  s_add_u32 s45, s44, 73728
  buffer_load_dwordx4 v5, s[48:51], s43 offen nt lds
  s_mov_b32 m0, s45
  s_add_u32 s44, s44, 4096
  buffer_load_dwordx4 v5, s[52:55], s43 offen nt lds
  s_add_u32 s43, s43, 294912
  s_mov_b32 m0, s44
  s_add_u32 s45, s44, 73728
  buffer_load_dwordx4 v5, s[48:51], s43 offen nt lds
  s_mov_b32 m0, s45
  s_add_u32 s44, s44, 4096
  buffer_load_dwordx4 v5, s[52:55], s43 offen nt lds
  s_add_u32 s43, s43, 294912
  v_lshrrev_b32 v6, 3, v4
  v_mul_u32_u24 v7, 1152, v6
  v_and_b32 v12, 7, v4
  v_lshl_add_u32 v236, v12, 4, v7
  v_bfe_u32 v14, v6, 1, 1
  v_bfe_u32 v11, v6, 3, 1
  v_lshl_add_u32 v14, v11, 1, v14
  v_lshlrev_b32 v14, 1, v14
  v_xor_b32 v14, v14, v12
  v_lshl_add_u32 v14, v14, 4, v7
  v_add_u32 v15, 36864, v14
  v_and_b32 v2, 15, v0
  v_bfe_u32 v3, v0, 4, 2
  v_lshrrev_b32 v10, 2, v2
  v_lshl_add_u32 v11, v3, 3, v10
  v_bfe_u32 v12, v2, 3, 1
  v_and_b32 v13, 1, v3
  v_lshl_add_u32 v12, v13, 1, v12
  v_xor_b32 v12, s42, v12
  v_and_b32 v13, 3, v2
  v_lshlrev_b32 v13, 3, v13
  v_lshl_add_u32 v12, v12, 5, v13
  v_lshl_add_u32 v5, v11, 7, v12
  v_add_u32 v6, 36864, v5
  v_mul_u32_u24 v7, 1152, v11
  v_add_u32 v7, v7, v12
  v_add_u32 v10, 36864, v7
  v_add_u32 v12, 73728, v5
  v_add_u32 v13, 73728, v6
  v_lshrrev_b32 v232, 3, v1
  v_mul_u32_u24 v232, 1152, v232
  v_bfe_u32 v233, v1, 4, 1
  s_and_b32 s43, s42, 1
  s_lshl_b32 s43, s43, 1
  v_or_b32 v233, s43, v233
  v_lshlrev_b32 v233, 1, v233
  v_and_b32 v234, 7, v1
  v_xor_b32 v233, v233, v234
  v_lshl_add_u32 v236, v233, 4, v232
  s_waitcnt vmcnt(24)
  s_mov_b64 exec, 1
  ds_add_u32 v8, v9 offset:0
  s_mov_b64 exec, -1
  s_mov_b32 s52, 0
L_lw_55:
  ds_read_b32 v11, v8 offset:0
  s_add_u32 s52, s52, 1
  s_waitcnt lgkmcnt(0)
  s_cmp_gt_u32 s52, 1600000
  v_readfirstlane_b32 s51, v11
  s_cbranch_scc1 L_lwd_56
  s_nop 1
  s_cmp_ge_u32 s51, 4
  s_cbranch_scc1 L_lwd_56
  s_branch L_lw_55
L_lwd_56:
  ds_read_b64_tr_b16 v[16:17], v5 offset:0
  ds_read_b64_tr_b16 v[18:19], v5 offset:512
  ds_read_b64_tr_b16 v[88:89], v12 offset:0
  ds_read_b64_tr_b16 v[90:91], v12 offset:512
  ds_read_b64_tr_b16 v[20:21], v5 offset:4096
  ds_read_b64_tr_b16 v[22:23], v5 offset:4608
  ds_read_b64_tr_b16 v[92:93], v12 offset:4096
  ds_read_b64_tr_b16 v[94:95], v12 offset:4608
  ds_read_b64_tr_b16 v[24:25], v5 offset:8192
  ds_read_b64_tr_b16 v[26:27], v5 offset:8704
  ds_read_b64_tr_b16 v[96:97], v12 offset:8192
  ds_read_b64_tr_b16 v[98:99], v12 offset:8704
  ds_read_b64_tr_b16 v[28:29], v5 offset:12288
  ds_read_b64_tr_b16 v[30:31], v5 offset:12800
  ds_read_b64_tr_b16 v[100:101], v12 offset:12288
  ds_read_b64_tr_b16 v[102:103], v12 offset:12800
  ds_read_b64_tr_b16 v[32:33], v5 offset:16384
  ds_read_b64_tr_b16 v[34:35], v5 offset:16896
  ds_read_b64_tr_b16 v[104:105], v12 offset:16384
  ds_read_b64_tr_b16 v[106:107], v12 offset:16896
  ds_read_b64_tr_b16 v[36:37], v5 offset:20480
  ds_read_b64_tr_b16 v[38:39], v5 offset:20992
  ds_read_b64_tr_b16 v[108:109], v12 offset:20480
  ds_read_b64_tr_b16 v[110:111], v12 offset:20992
  s_waitcnt vmcnt(12)
  s_mov_b64 exec, 1
  ds_add_u32 v8, v9 offset:28
  s_mov_b64 exec, -1
  s_mov_b32 s52, 0
L_lw_57:
  ds_read_b32 v11, v8 offset:28
  s_add_u32 s52, s52, 1
  s_waitcnt lgkmcnt(0)
  s_cmp_gt_u32 s52, 1600000
  v_readfirstlane_b32 s51, v11
  s_cbranch_scc1 L_lwd_58
  s_nop 1
  s_cmp_ge_u32 s51, 4
  s_cbranch_scc1 L_lwd_58
  s_branch L_lw_57
L_lwd_58:
  ds_read_b64_tr_b16 v[40:41], v5 offset:24576
  ds_read_b64_tr_b16 v[42:43], v5 offset:25088
  ds_read_b64_tr_b16 v[112:113], v12 offset:24576
  ds_read_b64_tr_b16 v[114:115], v12 offset:25088
  ds_read_b64_tr_b16 v[44:45], v5 offset:28672
  ds_read_b64_tr_b16 v[46:47], v5 offset:29184
  ds_read_b64_tr_b16 v[116:117], v12 offset:28672
  ds_read_b64_tr_b16 v[118:119], v12 offset:29184
  ds_read_b64_tr_b16 v[48:49], v5 offset:32768
  ds_read_b64_tr_b16 v[50:51], v5 offset:33280
  ds_read_b64_tr_b16 v[120:121], v12 offset:32768
  ds_read_b64_tr_b16 v[122:123], v12 offset:33280
  ds_read_b64_tr_b16 v[52:53], v6 offset:0
  ds_read_b64_tr_b16 v[54:55], v6 offset:512
  ds_read_b64_tr_b16 v[124:125], v13 offset:0
  ds_read_b64_tr_b16 v[126:127], v13 offset:512
  ds_read_b64_tr_b16 v[56:57], v6 offset:4096
  ds_read_b64_tr_b16 v[58:59], v6 offset:4608
  ds_read_b64_tr_b16 v[128:129], v13 offset:4096
  ds_read_b64_tr_b16 v[130:131], v13 offset:4608
  ds_read_b64_tr_b16 v[60:61], v6 offset:8192
  ds_read_b64_tr_b16 v[62:63], v6 offset:8704
  ds_read_b64_tr_b16 v[132:133], v13 offset:8192
  ds_read_b64_tr_b16 v[134:135], v13 offset:8704
  s_waitcnt lgkmcnt(0)
  s_mov_b64 exec, 1
  ds_add_u32 v8, v9 offset:4
  s_mov_b64 exec, -1
  s_mov_b32 s52, 0
L_lw_59:
  ds_read_b32 v11, v8 offset:4
  s_add_u32 s52, s52, 1
  s_waitcnt lgkmcnt(0)
  s_cmp_gt_u32 s52, 1600000
  v_readfirstlane_b32 s51, v11
  s_cbranch_scc1 L_lwd_60
  s_nop 1
  s_cmp_ge_u32 s51, 4
  s_cbranch_scc1 L_lwd_60
  s_branch L_lw_59
L_lwd_60:
  s_mul_i32 s43, s41, 73728
  s_mul_i32 s44, s42, 9216
  s_add_u32 s43, s43, s44
  s_mov_b32 m0, s44
  s_add_u32 s44, s44, 1024
  buffer_load_dwordx4 v236, s[56:59], s43 offen offset:0 nt lds
  s_add_u32 s43, s43, 128
  s_mov_b32 m0, s44
  s_add_u32 s44, s44, 1024
  buffer_load_dwordx4 v236, s[56:59], s43 offen offset:0 nt lds
  s_add_u32 s43, s43, 128
  s_mov_b32 m0, s44
  s_add_u32 s44, s44, 1024
  buffer_load_dwordx4 v236, s[56:59], s43 offen offset:0 nt lds
  s_add_u32 s43, s43, 128
  s_mov_b32 m0, s44
  s_add_u32 s44, s44, 1024
  buffer_load_dwordx4 v236, s[56:59], s43 offen offset:0 nt lds
  s_add_u32 s43, s43, 128
  s_mov_b32 m0, s44
  s_add_u32 s44, s44, 1024
  buffer_load_dwordx4 v236, s[56:59], s43 offen offset:0 nt lds
  s_add_u32 s43, s43, 128
  s_mov_b32 m0, s44
  s_add_u32 s44, s44, 1024
  buffer_load_dwordx4 v236, s[56:59], s43 offen offset:0 nt lds
  s_add_u32 s43, s43, 128
  s_mov_b32 m0, s44
  s_add_u32 s44, s44, 1024
  buffer_load_dwordx4 v236, s[56:59], s43 offen offset:0 nt lds
  s_add_u32 s43, s43, 128
  s_mov_b32 m0, s44
  s_add_u32 s44, s44, 1024
  buffer_load_dwordx4 v236, s[56:59], s43 offen offset:0 nt lds
  s_add_u32 s43, s43, 128
  s_mov_b32 m0, s44
  s_add_u32 s44, s44, 1024
  buffer_load_dwordx4 v236, s[56:59], s43 offen offset:0 nt lds
  s_add_u32 s43, s43, 128
  s_mul_i32 s43, s41, 73728
  s_mul_i32 s44, s42, 9216
  s_add_u32 s43, s43, s44
  s_add_u32 s43, s43, 36864
  s_add_u32 s44, s44, 73728
  s_mov_b32 m0, s44
  s_add_u32 s44, s44, 1024
  buffer_load_dwordx4 v236, s[56:59], s43 offen offset:0 nt lds
  s_add_u32 s43, s43, 128
  s_mov_b32 m0, s44
  s_add_u32 s44, s44, 1024
  buffer_load_dwordx4 v236, s[56:59], s43 offen offset:0 nt lds
  s_add_u32 s43, s43, 128
  s_mov_b32 m0, s44
  s_add_u32 s44, s44, 1024
  buffer_load_dwordx4 v236, s[56:59], s43 offen offset:0 nt lds
  s_add_u32 s43, s43, 128
  s_mov_b32 m0, s44
  s_add_u32 s44, s44, 1024
  buffer_load_dwordx4 v236, s[56:59], s43 offen offset:0 nt lds
  s_add_u32 s43, s43, 128
  s_mov_b32 m0, s44
  s_add_u32 s44, s44, 1024
  buffer_load_dwordx4 v236, s[56:59], s43 offen offset:0 nt lds
  s_add_u32 s43, s43, 128
  s_mov_b32 m0, s44
  s_add_u32 s44, s44, 1024
  buffer_load_dwordx4 v236, s[56:59], s43 offen offset:0 nt lds
  s_add_u32 s43, s43, 128
  s_mov_b32 m0, s44
  s_add_u32 s44, s44, 1024
  buffer_load_dwordx4 v236, s[56:59], s43 offen offset:0 nt lds
  s_add_u32 s43, s43, 128
  s_mov_b32 m0, s44
  s_add_u32 s44, s44, 1024
  buffer_load_dwordx4 v236, s[56:59], s43 offen offset:0 nt lds
  s_add_u32 s43, s43, 128
  s_mov_b32 m0, s44
  s_add_u32 s44, s44, 1024
  buffer_load_dwordx4 v236, s[56:59], s43 offen offset:0 nt lds
  s_add_u32 s43, s43, 128
  s_waitcnt vmcnt(18)
  s_mov_b64 exec, 1
  ds_add_u32 v8, v9 offset:24
  s_mov_b64 exec, -1
  s_mov_b32 s52, 0
L_lw_61:
  ds_read_b32 v11, v8 offset:24
  s_add_u32 s52, s52, 1
  s_waitcnt lgkmcnt(0)
  s_cmp_gt_u32 s52, 1600000
  v_readfirstlane_b32 s51, v11
  s_cbranch_scc1 L_lwd_62
  s_nop 1
  s_cmp_ge_u32 s51, 4
  s_cbranch_scc1 L_lwd_62
  s_branch L_lw_61
L_lwd_62:
  ds_read_b64_tr_b16 v[64:65], v6 offset:12288
  ds_read_b64_tr_b16 v[66:67], v6 offset:12800
  ds_read_b64_tr_b16 v[136:137], v13 offset:12288
  ds_read_b64_tr_b16 v[138:139], v13 offset:12800
  ds_read_b64_tr_b16 v[68:69], v6 offset:16384
  ds_read_b64_tr_b16 v[70:71], v6 offset:16896
  ds_read_b64_tr_b16 v[140:141], v13 offset:16384
  ds_read_b64_tr_b16 v[142:143], v13 offset:16896
  ds_read_b64_tr_b16 v[72:73], v6 offset:20480
  ds_read_b64_tr_b16 v[74:75], v6 offset:20992
  ds_read_b64_tr_b16 v[144:145], v13 offset:20480
  ds_read_b64_tr_b16 v[146:147], v13 offset:20992
  ds_read_b64_tr_b16 v[76:77], v6 offset:24576
  ds_read_b64_tr_b16 v[78:79], v6 offset:25088
  ds_read_b64_tr_b16 v[148:149], v13 offset:24576
  ds_read_b64_tr_b16 v[150:151], v13 offset:25088
  ds_read_b64_tr_b16 v[80:81], v6 offset:28672
  ds_read_b64_tr_b16 v[82:83], v6 offset:29184
  ds_read_b64_tr_b16 v[152:153], v13 offset:28672
  ds_read_b64_tr_b16 v[154:155], v13 offset:29184
  ds_read_b64_tr_b16 v[84:85], v6 offset:32768
  ds_read_b64_tr_b16 v[86:87], v6 offset:33280
  ds_read_b64_tr_b16 v[156:157], v13 offset:32768
  ds_read_b64_tr_b16 v[158:159], v13 offset:33280
  v_lshrrev_b32 v232, 2, v2
  v_mul_u32_u24 v14, 9216, v3
  v_lshl_add_u32 v14, v232, 7, v14
  v_bfe_u32 v233, v2, 3, 1
  v_and_b32 v234, 1, v3
  v_lshl_add_u32 v233, v234, 1, v233
  v_xor_b32 v233, s42, v233
  v_lshl_add_u32 v14, v233, 5, v14
  v_and_b32 v234, 3, v2
  v_lshl_add_u32 v14, v234, 3, v14
  v_add_u32 v15, 73728, v14
  v_and_b32 v12, 7, v2
  v_mul_u32_u24 v5, 1168, v12
  v_lshl_add_u32 v5, v3, 4, v5
  v_add_u32 v5, 147456, v5
  v_mul_u32_u24 v6, 144, v2
  v_lshl_add_u32 v6, v3, 3, v6
  s_lshl_b32 s43, s42, 5
  s_add_u32 s43, s43, 156800
  v_add_u32 v6, s43, v6
  v_mul_u32_u24 v7, 144, v12
  v_lshl_add_u32 v7, v3, 4, v7
  v_add_u32 v7, 156800, v7
  v_mul_u32_u24 v10, 2304, v12
  v_lshl_add_u32 v10, v3, 4, v10
  v_bfe_u32 v13, v2, 3, 1
  v_lshl_add_u32 v10, v13, 8, v10
  v_cmp_eq_u32 s[56:57], 1, v13
  s_mul_i32 s43, s41, 18432
  s_lshl_b32 s44, s42, 6
  s_add_u32 s43, s43, s44
  s_add_u32 s43, s43, 5242880
  v_mov_b32 v13, 162304
  v_mov_b32 v232, 0
  v_mov_b32 v233, 0
  v_mov_b32 v234, 0
  v_mov_b32 v235, 0
  v_mov_b32 v236, 0
  v_mov_b32 v237, 0
  v_mov_b32 v238, 0
  v_mov_b32 v239, 0
  s_waitcnt lgkmcnt(0)
  s_mov_b32 s14, 0
  s_mov_b32 s15, 0
  ds_read_b32 v11, v8 offset:16
  s_waitcnt lgkmcnt(0)
  v_readfirstlane_b32 s51, v11
  s_nop 3
  s_cmp_ge_u32 s51, 4
  s_cbranch_scc1 L_Gb_64
L_Wb_63:
  s_waitcnt vmcnt(0)
  s_mov_b64 exec, 1
  ds_add_u32 v8, v9 offset:8
  s_mov_b64 exec, -1
  s_mov_b32 s52, 0
L_lw_66:
  ds_read_b32 v11, v8 offset:8
  s_add_u32 s52, s52, 1
  s_waitcnt lgkmcnt(0)
  s_cmp_gt_u32 s52, 1600000
  v_readfirstlane_b32 s51, v11
  s_cbranch_scc1 L_lwd_67
  s_nop 1
  s_cmp_ge_u32 s51, 4
  s_cbranch_scc1 L_lwd_67
  s_branch L_lw_66
L_lwd_67:
  ds_read_b64_tr_b16 v[160:161], v14 offset:0
  ds_read_b64_tr_b16 v[162:163], v14 offset:512
  ds_read_b64_tr_b16 v[164:165], v15 offset:0
  ds_read_b64_tr_b16 v[166:167], v15 offset:512
  ds_read_b64_tr_b16 v[168:169], v14 offset:1024
  ds_read_b64_tr_b16 v[170:171], v14 offset:1536
  ds_read_b64_tr_b16 v[172:173], v15 offset:1024
  ds_read_b64_tr_b16 v[174:175], v15 offset:1536
  ds_read_b64_tr_b16 v[176:177], v14 offset:2048
  ds_read_b64_tr_b16 v[178:179], v14 offset:2560
  ds_read_b64_tr_b16 v[180:181], v15 offset:2048
  ds_read_b64_tr_b16 v[182:183], v15 offset:2560
  ds_read_b64_tr_b16 v[184:185], v14 offset:3072
  ds_read_b64_tr_b16 v[186:187], v14 offset:3584
  ds_read_b64_tr_b16 v[188:189], v15 offset:3072
  ds_read_b64_tr_b16 v[190:191], v15 offset:3584
  ds_read_b64_tr_b16 v[192:193], v14 offset:4096
  ds_read_b64_tr_b16 v[194:195], v14 offset:4608
  ds_read_b64_tr_b16 v[196:197], v15 offset:4096
  ds_read_b64_tr_b16 v[198:199], v15 offset:4608
  ds_read_b64_tr_b16 v[200:201], v14 offset:5120
  ds_read_b64_tr_b16 v[202:203], v14 offset:5632
  ds_read_b64_tr_b16 v[204:205], v15 offset:5120
  ds_read_b64_tr_b16 v[206:207], v15 offset:5632
  ds_read_b64_tr_b16 v[208:209], v14 offset:6144
  ds_read_b64_tr_b16 v[210:211], v14 offset:6656
  ds_read_b64_tr_b16 v[212:213], v15 offset:6144
  ds_read_b64_tr_b16 v[214:215], v15 offset:6656
  ds_read_b64_tr_b16 v[216:217], v14 offset:7168
  ds_read_b64_tr_b16 v[218:219], v14 offset:7680
  ds_read_b64_tr_b16 v[220:221], v15 offset:7168
  ds_read_b64_tr_b16 v[222:223], v15 offset:7680
  ds_read_b64_tr_b16 v[224:225], v14 offset:8192
  ds_read_b64_tr_b16 v[226:227], v14 offset:8704
  ds_read_b64_tr_b16 v[228:229], v15 offset:8192
  ds_read_b64_tr_b16 v[230:231], v15 offset:8704
  s_waitcnt lgkmcnt(0)
  s_mov_b32 s14, 1
  s_cmp_eq_u32 s15, 1
  s_cbranch_scc1 L_Db_65
L_Gb_64:
  s_mov_b32 s52, 0
L_lw_68:
  ds_read_b32 v11, v8 offset:16
  s_add_u32 s52, s52, 1
  s_waitcnt lgkmcnt(0)
  s_cmp_gt_u32 s52, 1600000
  v_readfirstlane_b32 s51, v11
  s_cbranch_scc1 L_lwd_69
  s_nop 1
  s_cmp_ge_u32 s51, 4
  s_cbranch_scc1 L_lwd_69
  s_branch L_lw_68
L_lwd_69:
  ds_read_b32 v12, v13
  ds_read_b128 v[240:243], v5 offset:0
  ds_read_b128 v[244:247], v5 offset:64
  ds_read_b128 v[248:251], v5 offset:128
  ds_read_b128 v[252:255], v5 offset:192
  s_waitcnt lgkmcnt(3)
  v_mfma_f32_16x16x32_bf16 v[232:235], v[16:19], v[240:243], v[232:235]
  v_mfma_f32_16x16x32_bf16 v[236:239], v[88:91], v[240:243], v[236:239]
  ds_read_b128 v[240:243], v5 offset:256
  s_waitcnt lgkmcnt(3)
  v_mfma_f32_16x16x32_bf16 v[232:235], v[20:23], v[244:247], v[232:235]
  v_mfma_f32_16x16x32_bf16 v[236:239], v[92:95], v[244:247], v[236:239]
  ds_read_b128 v[244:247], v5 offset:320
  s_waitcnt lgkmcnt(3)
  v_mfma_f32_16x16x32_bf16 v[232:235], v[24:27], v[248:251], v[232:235]
  v_mfma_f32_16x16x32_bf16 v[236:239], v[96:99], v[248:251], v[236:239]
  ds_read_b128 v[248:251], v5 offset:384
  s_waitcnt lgkmcnt(3)
  v_mfma_f32_16x16x32_bf16 v[232:235], v[28:31], v[252:255], v[232:235]
  v_mfma_f32_16x16x32_bf16 v[236:239], v[100:103], v[252:255], v[236:239]
  ds_read_b128 v[252:255], v5 offset:448
  s_waitcnt lgkmcnt(3)
  v_mfma_f32_16x16x32_bf16 v[232:235], v[32:35], v[240:243], v[232:235]
  v_mfma_f32_16x16x32_bf16 v[236:239], v[104:107], v[240:243], v[236:239]
  ds_read_b128 v[240:243], v5 offset:512
  s_waitcnt lgkmcnt(3)
  v_mfma_f32_16x16x32_bf16 v[232:235], v[36:39], v[244:247], v[232:235]
  v_mfma_f32_16x16x32_bf16 v[236:239], v[108:111], v[244:247], v[236:239]
  ds_read_b128 v[244:247], v5 offset:576
  s_waitcnt lgkmcnt(3)
  v_mfma_f32_16x16x32_bf16 v[232:235], v[40:43], v[248:251], v[232:235]
  v_mfma_f32_16x16x32_bf16 v[236:239], v[112:115], v[248:251], v[236:239]
  ds_read_b128 v[248:251], v5 offset:640
  s_waitcnt lgkmcnt(3)
  v_mfma_f32_16x16x32_bf16 v[232:235], v[44:47], v[252:255], v[232:235]
  v_mfma_f32_16x16x32_bf16 v[236:239], v[116:119], v[252:255], v[236:239]
  ds_read_b128 v[252:255], v5 offset:704
  s_waitcnt lgkmcnt(3)
  v_mfma_f32_16x16x32_bf16 v[232:235], v[48:51], v[240:243], v[232:235]
  v_mfma_f32_16x16x32_bf16 v[236:239], v[120:123], v[240:243], v[236:239]
  ds_read_b128 v[240:243], v5 offset:768
  s_waitcnt lgkmcnt(3)
  v_mfma_f32_16x16x32_bf16 v[232:235], v[52:55], v[244:247], v[232:235]
  v_mfma_f32_16x16x32_bf16 v[236:239], v[124:127], v[244:247], v[236:239]
  ds_read_b128 v[244:247], v5 offset:832
  s_waitcnt lgkmcnt(3)
  v_mfma_f32_16x16x32_bf16 v[232:235], v[56:59], v[248:251], v[232:235]
  v_mfma_f32_16x16x32_bf16 v[236:239], v[128:131], v[248:251], v[236:239]
  ds_read_b128 v[248:251], v5 offset:896
  s_waitcnt lgkmcnt(3)
  v_mfma_f32_16x16x32_bf16 v[232:235], v[60:63], v[252:255], v[232:235]
  v_mfma_f32_16x16x32_bf16 v[236:239], v[132:135], v[252:255], v[236:239]
  ds_read_b128 v[252:255], v5 offset:960
  s_waitcnt lgkmcnt(3)
  v_mfma_f32_16x16x32_bf16 v[232:235], v[64:67], v[240:243], v[232:235]
  v_mfma_f32_16x16x32_bf16 v[236:239], v[136:139], v[240:243], v[236:239]
  ds_read_b128 v[240:243], v5 offset:1024
  s_waitcnt lgkmcnt(3)
  v_mfma_f32_16x16x32_bf16 v[232:235], v[68:71], v[244:247], v[232:235]
  v_mfma_f32_16x16x32_bf16 v[236:239], v[140:143], v[244:247], v[236:239]
  ds_read_b128 v[244:247], v5 offset:1088
  s_waitcnt lgkmcnt(3)
  v_mfma_f32_16x16x32_bf16 v[232:235], v[72:75], v[248:251], v[232:235]
  v_mfma_f32_16x16x32_bf16 v[236:239], v[144:147], v[248:251], v[236:239]
  s_waitcnt lgkmcnt(2)
  v_mfma_f32_16x16x32_bf16 v[232:235], v[76:79], v[252:255], v[232:235]
  v_mfma_f32_16x16x32_bf16 v[236:239], v[148:151], v[252:255], v[236:239]
  s_waitcnt lgkmcnt(1)
  v_mfma_f32_16x16x32_bf16 v[232:235], v[80:83], v[240:243], v[232:235]
  v_mfma_f32_16x16x32_bf16 v[236:239], v[152:155], v[240:243], v[236:239]
  s_waitcnt lgkmcnt(0)
  v_mfma_f32_16x16x32_bf16 v[232:235], v[84:87], v[244:247], v[232:235]
  v_mfma_f32_16x16x32_bf16 v[236:239], v[156:159], v[244:247], v[236:239]
  v_readfirstlane_b32 s46, v12
  s_nop 5
  v_mul_f32 v20, 0xbfb8aa3b, v232
  v_mul_f32 v21, 0xbfb8aa3b, v233
  v_mul_f32 v22, 0xbfb8aa3b, v234
  v_mul_f32 v23, 0xbfb8aa3b, v235
  v_exp_f32 v20, v20
  v_exp_f32 v21, v21
  v_exp_f32 v22, v22
  v_exp_f32 v23, v23
  v_mul_f32 v232, v232, v236
  v_mul_f32 v233, v233, v237
  v_mul_f32 v234, v234, v238
  v_mul_f32 v235, v235, v239
  v_add_f32 v20, 1.0, v20
  v_add_f32 v21, 1.0, v21
  v_add_f32 v22, 1.0, v22
  v_add_f32 v23, 1.0, v23
  v_rcp_f32 v20, v20
  v_rcp_f32 v21, v21
  v_rcp_f32 v22, v22
  v_rcp_f32 v23, v23
  s_nop 0
  v_mul_f32 v232, v232, v20
  v_mul_f32 v233, v233, v21
  v_mul_f32 v234, v234, v22
  v_mul_f32 v235, v235, v23
  s_nop 0
  v_cvt_pk_bf16_f32 v16, v232, v233
  v_cvt_pk_bf16_f32 v17, v234, v235
  v_cmp_gt_u32 vcc, 8, v2
  s_and_saveexec_b64 s[44:45], vcc
  ds_write_b64 v6, v[16:17]
  s_mov_b64 exec, s[44:45]
  s_mov_b32 s58, 0xffffff00
  s_movk_i32 s59, 0x80
  s_waitcnt lgkmcnt(0)
  s_mov_b64 exec, 1
  ds_add_u32 v8, v9 offset:20
  s_mov_b64 exec, -1
  s_mov_b32 s15, 1
  s_cmp_eq_u32 s14, 0
  s_cbranch_scc1 L_Wb_63
L_Db_65:
  s_mov_b32 s52, 0
L_lw_70:
  ds_read_b32 v11, v8 offset:20
  s_add_u32 s52, s52, 1
  s_waitcnt lgkmcnt(0)
  s_cmp_gt_u32 s52, 1600000
  v_readfirstlane_b32 s51, v11
  s_cbranch_scc1 L_lwd_71
  s_nop 1
  s_cmp_ge_u32 s51, 4
  s_cbranch_scc1 L_lwd_71
  s_branch L_lw_70
L_lwd_71:
  ds_read_b128 v[16:19], v7
  ds_read_b128 v[20:23], v7 offset:64
  s_waitcnt lgkmcnt(0)
  v_mfma_f32_16x16x32_bf16 v[88:91], v[160:163], v[16:19], 0
  v_mfma_f32_16x16x32_bf16 v[92:95], v[168:171], v[16:19], 0
  v_mfma_f32_16x16x32_bf16 v[96:99], v[176:179], v[16:19], 0
  v_mfma_f32_16x16x32_bf16 v[100:103], v[184:187], v[16:19], 0
  v_mfma_f32_16x16x32_bf16 v[104:107], v[192:195], v[16:19], 0
  v_mfma_f32_16x16x32_bf16 v[108:111], v[200:203], v[16:19], 0
  v_mfma_f32_16x16x32_bf16 v[112:115], v[208:211], v[16:19], 0
  v_mfma_f32_16x16x32_bf16 v[116:119], v[216:219], v[16:19], 0
  v_mfma_f32_16x16x32_bf16 v[120:123], v[224:227], v[16:19], 0
  v_mfma_f32_16x16x32_bf16 v[88:91], v[164:167], v[20:23], v[88:91]
  v_mfma_f32_16x16x32_bf16 v[92:95], v[172:175], v[20:23], v[92:95]
  v_mfma_f32_16x16x32_bf16 v[96:99], v[180:183], v[20:23], v[96:99]
  v_mfma_f32_16x16x32_bf16 v[100:103], v[188:191], v[20:23], v[100:103]
  v_mfma_f32_16x16x32_bf16 v[104:107], v[196:199], v[20:23], v[104:107]
  v_mfma_f32_16x16x32_bf16 v[108:111], v[204:207], v[20:23], v[108:111]
  v_mfma_f32_16x16x32_bf16 v[112:115], v[212:215], v[20:23], v[112:115]
  v_mfma_f32_16x16x32_bf16 v[116:119], v[220:223], v[20:23], v[116:119]
  v_mfma_f32_16x16x32_bf16 v[120:123], v[228:231], v[20:23], v[120:123]
  s_nop 3
  v_cndmask_b32 v24, v88, v92, s[56:57]
  v_cndmask_b32 v25, v89, v93, s[56:57]
  v_cndmask_b32 v26, v90, v94, s[56:57]
  v_cndmask_b32 v27, v91, v95, s[56:57]
  v_add_u32 v24, s59, v24
  v_add_u32 v25, s59, v25
  v_add_u32 v26, s59, v26
  v_add_u32 v27, s59, v27
  v_lshrrev_b32 v28, 24, v27
  v_lshrrev_b32 v29, 16, v27
  v_lshrrev_b32 v30, 8, v27
  v_bfi_b32 v28, s58, v24, v28
  v_bfi_b32 v29, s58, v25, v29
  v_bfi_b32 v30, s58, v26, v30
  v_xor_b32 v31, v28, v29
  v_xor_b32 v31, v31, v30
  v_xor_b32 v31, s46, v31
  buffer_store_dwordx4 v[28:31], v10, s[36:39], s43 offen offset:0 sc1
  v_cndmask_b32 v32, v96, v100, s[56:57]
  v_cndmask_b32 v33, v97, v101, s[56:57]
  v_cndmask_b32 v34, v98, v102, s[56:57]
  v_cndmask_b32 v35, v99, v103, s[56:57]
  v_add_u32 v32, s59, v32
  v_add_u32 v33, s59, v33
  v_add_u32 v34, s59, v34
  v_add_u32 v35, s59, v35
  v_lshrrev_b32 v36, 24, v35
  v_lshrrev_b32 v37, 16, v35
  v_lshrrev_b32 v38, 8, v35
  v_bfi_b32 v36, s58, v32, v36
  v_bfi_b32 v37, s58, v33, v37
  v_bfi_b32 v38, s58, v34, v38
  v_xor_b32 v39, v36, v37
  v_xor_b32 v39, v39, v38
  v_xor_b32 v39, s46, v39
  buffer_store_dwordx4 v[36:39], v10, s[36:39], s43 offen offset:512 sc1
  v_cndmask_b32 v40, v104, v108, s[56:57]
  v_cndmask_b32 v41, v105, v109, s[56:57]
  v_cndmask_b32 v42, v106, v110, s[56:57]
  v_cndmask_b32 v43, v107, v111, s[56:57]
  v_add_u32 v40, s59, v40
  v_add_u32 v41, s59, v41
  v_add_u32 v42, s59, v42
  v_add_u32 v43, s59, v43
  v_lshrrev_b32 v44, 24, v43
  v_lshrrev_b32 v45, 16, v43
  v_lshrrev_b32 v46, 8, v43
  v_bfi_b32 v44, s58, v40, v44
  v_bfi_b32 v45, s58, v41, v45
  v_bfi_b32 v46, s58, v42, v46
  v_xor_b32 v47, v44, v45
  v_xor_b32 v47, v47, v46
  v_xor_b32 v47, s46, v47
  buffer_store_dwordx4 v[44:47], v10, s[36:39], s43 offen offset:1024 sc1
  v_cndmask_b32 v48, v112, v116, s[56:57]
  v_cndmask_b32 v49, v113, v117, s[56:57]
  v_cndmask_b32 v50, v114, v118, s[56:57]
  v_cndmask_b32 v51, v115, v119, s[56:57]
  v_add_u32 v48, s59, v48
  v_add_u32 v49, s59, v49
  v_add_u32 v50, s59, v50
  v_add_u32 v51, s59, v51
  v_lshrrev_b32 v52, 24, v51
  v_lshrrev_b32 v53, 16, v51
  v_lshrrev_b32 v54, 8, v51
  v_bfi_b32 v52, s58, v48, v52
  v_bfi_b32 v53, s58, v49, v53
  v_bfi_b32 v54, s58, v50, v54
  v_xor_b32 v55, v52, v53
  v_xor_b32 v55, v55, v54
  v_xor_b32 v55, s46, v55
  buffer_store_dwordx4 v[52:55], v10, s[36:39], s43 offen offset:1536 sc1
  v_cndmask_b32 v56, v120, v120, s[56:57]
  v_cndmask_b32 v57, v121, v121, s[56:57]
  v_cndmask_b32 v58, v122, v122, s[56:57]
  v_cndmask_b32 v59, v123, v123, s[56:57]
  v_add_u32 v56, s59, v56
  v_add_u32 v57, s59, v57
  v_add_u32 v58, s59, v58
  v_add_u32 v59, s59, v59
  v_lshrrev_b32 v60, 24, v59
  v_lshrrev_b32 v61, 16, v59
  v_lshrrev_b32 v62, 8, v59
  v_bfi_b32 v60, s58, v56, v60
  v_bfi_b32 v61, s58, v57, v61
  v_bfi_b32 v62, s58, v58, v62
  v_xor_b32 v63, v60, v61
  v_xor_b32 v63, v63, v62
  v_xor_b32 v63, s46, v63
  s_andn2_b64 exec, exec, s[56:57]
  buffer_store_dwordx4 v[60:63], v10, s[36:39], s43 offen offset:2048 sc1
  s_mov_b64 exec, -1
  s_endpgm
L_twave_54:
  s_setprio 3
  s_lshl_b32 s60, s41, 2
  s_add_u32 s60, s60, s42
  s_sub_u32 s60, s60, 4
  s_mov_b32 s48, s72
  s_and_b32 s49, s73, 0xffff
  s_mov_b32 s50, 0x240000
  s_mov_b32 s51, 0x00020000
  s_mov_b32 s56, s86
  s_and_b32 s57, s87, 0xffff
  s_mov_b32 s58, 0x480
  s_mov_b32 s59, 0x00020000
  v_and_b32 v1, 63, v0
  v_and_b32 v2, 15, v0
  v_lshrrev_b32 v3, 4, v1
  s_lshl_b32 s61, s60, 2
  v_add_u32 v30, s61, v3
  s_movk_i32 s62, 1152
  v_mul_lo_u32 v6, v30, s62
  v_lshl_add_u32 v6, v2, 3, v6
  v_lshlrev_b32 v7, 3, v2
  buffer_load_dwordx2 v[64:65], v6, s[48:51], 0 offen offset:0 nt
  buffer_load_dwordx2 v[66:67], v6, s[48:51], 0 offen offset:128 nt
  buffer_load_dwordx2 v[68:69], v6, s[48:51], 0 offen offset:256 nt
  buffer_load_dwordx2 v[70:71], v6, s[48:51], 0 offen offset:384 nt
  buffer_load_dwordx2 v[72:73], v6, s[48:51], 0 offen offset:512 nt
  buffer_load_dwordx2 v[74:75], v6, s[48:51], 0 offen offset:640 nt
  buffer_load_dwordx2 v[76:77], v6, s[48:51], 0 offen offset:768 nt
  buffer_load_dwordx2 v[78:79], v6, s[48:51], 0 offen offset:896 nt
  buffer_load_dwordx2 v[80:81], v6, s[48:51], 0 offen offset:1024 nt
  buffer_load_dwordx2 v[84:85], v7, s[56:59], 0 offen offset:0
  buffer_load_dwordx2 v[86:87], v7, s[56:59], 0 offen offset:128
  buffer_load_dwordx2 v[88:89], v7, s[56:59], 0 offen offset:256
  buffer_load_dwordx2 v[90:91], v7, s[56:59], 0 offen offset:384
  buffer_load_dwordx2 v[92:93], v7, s[56:59], 0 offen offset:512
  buffer_load_dwordx2 v[94:95], v7, s[56:59], 0 offen offset:640
  buffer_load_dwordx2 v[96:97], v7, s[56:59], 0 offen offset:768
  buffer_load_dwordx2 v[98:99], v7, s[56:59], 0 offen offset:896
  buffer_load_dwordx2 v[100:101], v7, s[56:59], 0 offen offset:1024
  s_barrier
  s_waitcnt lgkmcnt(0)
  s_mul_i32 s46, s46, 0x9E3779B1
  s_add_u32 s46, s46, 0x7F4A7C15
  s_waitcnt vmcnt(0)
L_lnb_72:
  v_lshlrev_b32 v104, 16, v64
  v_and_b32 v105, s40, v64
  v_lshlrev_b32 v106, 16, v65
  v_and_b32 v107, s40, v65
  v_lshlrev_b32 v108, 16, v66
  v_and_b32 v109, s40, v66
  v_lshlrev_b32 v110, 16, v67
  v_and_b32 v111, s40, v67
  v_lshlrev_b32 v112, 16, v68
  v_and_b32 v113, s40, v68
  v_lshlrev_b32 v114, 16, v69
  v_and_b32 v115, s40, v69
  v_lshlrev_b32 v116, 16, v70
  v_and_b32 v117, s40, v70
  v_lshlrev_b32 v118, 16, v71
  v_and_b32 v119, s40, v71
  v_lshlrev_b32 v120, 16, v72
  v_and_b32 v121, s40, v72
  v_lshlrev_b32 v122, 16, v73
  v_and_b32 v123, s40, v73
  v_lshlrev_b32 v124, 16, v74
  v_and_b32 v125, s40, v74
  v_lshlrev_b32 v126, 16, v75
  v_and_b32 v127, s40, v75
  v_lshlrev_b32 v128, 16, v76
  v_and_b32 v129, s40, v76
  v_lshlrev_b32 v130, 16, v77
  v_and_b32 v131, s40, v77
  v_lshlrev_b32 v132, 16, v78
  v_and_b32 v133, s40, v78
  v_lshlrev_b32 v134, 16, v79
  v_and_b32 v135, s40, v79
  v_lshlrev_b32 v136, 16, v80
  v_and_b32 v137, s40, v80
  v_lshlrev_b32 v138, 16, v81
  v_and_b32 v139, s40, v81
  v_pk_add_f32 v[8:9], v[104:105], v[106:107]
  v_pk_add_f32 v[10:11], v[108:109], v[110:111]
  v_pk_add_f32 v[8:9], v[8:9], v[112:113]
  v_pk_add_f32 v[10:11], v[10:11], v[114:115]
  v_pk_add_f32 v[8:9], v[8:9], v[116:117]
  v_pk_add_f32 v[10:11], v[10:11], v[118:119]
  v_pk_add_f32 v[8:9], v[8:9], v[120:121]
  v_pk_add_f32 v[10:11], v[10:11], v[122:123]
  v_pk_add_f32 v[8:9], v[8:9], v[124:125]
  v_pk_add_f32 v[10:11], v[10:11], v[126:127]
  v_pk_add_f32 v[8:9], v[8:9], v[128:129]
  v_pk_add_f32 v[10:11], v[10:11], v[130:131]
  v_pk_add_f32 v[8:9], v[8:9], v[132:133]
  v_pk_add_f32 v[10:11], v[10:11], v[134:135]
  v_pk_add_f32 v[8:9], v[8:9], v[136:137]
  v_pk_add_f32 v[10:11], v[10:11], v[138:139]
  v_pk_add_f32 v[8:9], v[8:9], v[10:11]
  s_nop 0
  v_add_f32 v8, v8, v9
  s_nop 1
  v_add_f32_dpp v8, v8, v8 quad_perm:[1,0,3,2] row_mask:0xf bank_mask:0xf
  s_nop 1
  v_add_f32_dpp v8, v8, v8 quad_perm:[2,3,0,1] row_mask:0xf bank_mask:0xf
  s_nop 1
  v_add_f32_dpp v8, v8, v8 row_half_mirror row_mask:0xf bank_mask:0xf
  s_nop 1
  v_add_f32_dpp v8, v8, v8 row_mirror row_mask:0xf bank_mask:0xf
  v_mul_f32 v8, 0x3ae38e39, v8
  v_sub_f32 v12, 0, v8
  v_sub_f32 v13, 0, v8
  v_mov_b32 v14, 0
  v_mov_b32 v15, 0
  v_mov_b32 v16, 0
  v_mov_b32 v17, 0
  v_pk_add_f32 v[18:19], v[104:105], v[12:13]
  v_pk_add_f32 v[20:21], v[106:107], v[12:13]
  v_pk_fma_f32 v[14:15], v[18:19], v[18:19], v[14:15]
  v_pk_fma_f32 v[16:17], v[20:21], v[20:21], v[16:17]
  v_pk_add_f32 v[18:19], v[108:109], v[12:13]
  v_pk_add_f32 v[20:21], v[110:111], v[12:13]
  v_pk_fma_f32 v[14:15], v[18:19], v[18:19], v[14:15]
  v_pk_fma_f32 v[16:17], v[20:21], v[20:21], v[16:17]
  v_pk_add_f32 v[18:19], v[112:113], v[12:13]
  v_pk_add_f32 v[20:21], v[114:115], v[12:13]
  v_pk_fma_f32 v[14:15], v[18:19], v[18:19], v[14:15]
  v_pk_fma_f32 v[16:17], v[20:21], v[20:21], v[16:17]
  v_pk_add_f32 v[18:19], v[116:117], v[12:13]
  v_pk_add_f32 v[20:21], v[118:119], v[12:13]
  v_pk_fma_f32 v[14:15], v[18:19], v[18:19], v[14:15]
  v_pk_fma_f32 v[16:17], v[20:21], v[20:21], v[16:17]
  v_pk_add_f32 v[18:19], v[120:121], v[12:13]
  v_pk_add_f32 v[20:21], v[122:123], v[12:13]
  v_pk_fma_f32 v[14:15], v[18:19], v[18:19], v[14:15]
  v_pk_fma_f32 v[16:17], v[20:21], v[20:21], v[16:17]
  v_pk_add_f32 v[18:19], v[124:125], v[12:13]
  v_pk_add_f32 v[20:21], v[126:127], v[12:13]
  v_pk_fma_f32 v[14:15], v[18:19], v[18:19], v[14:15]
  v_pk_fma_f32 v[16:17], v[20:21], v[20:21], v[16:17]
  v_pk_add_f32 v[18:19], v[128:129], v[12:13]
  v_pk_add_f32 v[20:21], v[130:131], v[12:13]
  v_pk_fma_f32 v[14:15], v[18:19], v[18:19], v[14:15]
  v_pk_fma_f32 v[16:17], v[20:21], v[20:21], v[16:17]
  v_pk_add_f32 v[18:19], v[132:133], v[12:13]
  v_pk_add_f32 v[20:21], v[134:135], v[12:13]
  v_pk_fma_f32 v[14:15], v[18:19], v[18:19], v[14:15]
  v_pk_fma_f32 v[16:17], v[20:21], v[20:21], v[16:17]
  v_pk_add_f32 v[18:19], v[136:137], v[12:13]
  v_pk_add_f32 v[20:21], v[138:139], v[12:13]
  v_pk_fma_f32 v[14:15], v[18:19], v[18:19], v[14:15]
  v_pk_fma_f32 v[16:17], v[20:21], v[20:21], v[16:17]
  v_pk_add_f32 v[14:15], v[14:15], v[16:17]
  s_nop 0
  v_add_f32 v14, v14, v15
  s_nop 1
  v_add_f32_dpp v14, v14, v14 quad_perm:[1,0,3,2] row_mask:0xf bank_mask:0xf
  s_nop 1
  v_add_f32_dpp v14, v14, v14 quad_perm:[2,3,0,1] row_mask:0xf bank_mask:0xf
  s_nop 1
  v_add_f32_dpp v14, v14, v14 row_half_mirror row_mask:0xf bank_mask:0xf
  s_nop 1
  v_add_f32_dpp v14, v14, v14 row_mirror row_mask:0xf bank_mask:0xf
  v_mul_f32 v14, 0x3ae38e39, v14
  s_nop 0
  v_cvt_pk_bf16_f32 v9, v8, v14
  v_lshlrev_b32 v8, 16, v9
  v_and_b32 v14, s40, v9
  v_add_f32 v14, 0x3727c5ac, v14
  s_nop 0
  v_cvt_pk_bf16_f32 v9, v14, v14
  v_lshlrev_b32 v14, 16, v9
  v_sqrt_f32 v14, v14
  s_nop 0
  v_cvt_pk_bf16_f32 v9, v14, v14
  v_lshlrev_b32 v14, 16, v9
  v_rcp_f32 v15, v14
  s_nop 0
  v_fma_f32 v16, -v14, v15, 1.0
  v_fma_f32 v15, v16, v15, v15
  v_sub_f32 v12, 0, v8
  v_sub_f32 v13, 0, v8
  v_mov_b32 v16, v15
  v_mov_b32 v17, v15
  v_mov_b32 v22, 0
  v_mov_b32 v23, 0
  v_mov_b32 v24, 0
  v_mov_b32 v25, 0
  v_pk_add_f32 v[104:105], v[104:105], v[12:13]
  v_pk_add_f32 v[106:107], v[106:107], v[12:13]
  v_cvt_pk_bf16_f32 v26, v104, v105
  v_cvt_pk_bf16_f32 v32, v106, v107
  v_lshlrev_b32 v104, 16, v26
  v_lshlrev_b32 v106, 16, v32
  v_and_b32 v105, s40, v26
  v_and_b32 v107, s40, v32
  v_pk_mul_f32 v[104:105], v[104:105], v[16:17]
  v_pk_mul_f32 v[106:107], v[106:107], v[16:17]
  v_cvt_pk_bf16_f32 v26, v104, v105
  v_cvt_pk_bf16_f32 v32, v106, v107
  v_lshlrev_b32 v104, 16, v26
  v_lshlrev_b32 v106, 16, v32
  v_and_b32 v105, s40, v26
  v_and_b32 v107, s40, v32
  v_lshlrev_b32 v28, 16, v84
  v_lshlrev_b32 v34, 16, v85
  v_and_b32 v29, s40, v84
  v_and_b32 v35, s40, v85
  v_pk_fma_f32 v[22:23], v[104:105], v[28:29], v[22:23]
  v_pk_fma_f32 v[24:25], v[106:107], v[34:35], v[24:25]
  v_pk_add_f32 v[108:109], v[108:109], v[12:13]
  v_pk_add_f32 v[110:111], v[110:111], v[12:13]
  v_cvt_pk_bf16_f32 v26, v108, v109
  v_cvt_pk_bf16_f32 v32, v110, v111
  v_lshlrev_b32 v108, 16, v26
  v_lshlrev_b32 v110, 16, v32
  v_and_b32 v109, s40, v26
  v_and_b32 v111, s40, v32
  v_pk_mul_f32 v[108:109], v[108:109], v[16:17]
  v_pk_mul_f32 v[110:111], v[110:111], v[16:17]
  v_cvt_pk_bf16_f32 v26, v108, v109
  v_cvt_pk_bf16_f32 v32, v110, v111
  v_lshlrev_b32 v108, 16, v26
  v_lshlrev_b32 v110, 16, v32
  v_and_b32 v109, s40, v26
  v_and_b32 v111, s40, v32
  v_lshlrev_b32 v28, 16, v86
  v_lshlrev_b32 v34, 16, v87
  v_and_b32 v29, s40, v86
  v_and_b32 v35, s40, v87
  v_pk_fma_f32 v[22:23], v[108:109], v[28:29], v[22:23]
  v_pk_fma_f32 v[24:25], v[110:111], v[34:35], v[24:25]
  v_pk_add_f32 v[112:113], v[112:113], v[12:13]
  v_pk_add_f32 v[114:115], v[114:115], v[12:13]
  v_cvt_pk_bf16_f32 v26, v112, v113
  v_cvt_pk_bf16_f32 v32, v114, v115
  v_lshlrev_b32 v112, 16, v26
  v_lshlrev_b32 v114, 16, v32
  v_and_b32 v113, s40, v26
  v_and_b32 v115, s40, v32
  v_pk_mul_f32 v[112:113], v[112:113], v[16:17]
  v_pk_mul_f32 v[114:115], v[114:115], v[16:17]
  v_cvt_pk_bf16_f32 v26, v112, v113
  v_cvt_pk_bf16_f32 v32, v114, v115
  v_lshlrev_b32 v112, 16, v26
  v_lshlrev_b32 v114, 16, v32
  v_and_b32 v113, s40, v26
  v_and_b32 v115, s40, v32
  v_lshlrev_b32 v28, 16, v88
  v_lshlrev_b32 v34, 16, v89
  v_and_b32 v29, s40, v88
  v_and_b32 v35, s40, v89
  v_pk_fma_f32 v[22:23], v[112:113], v[28:29], v[22:23]
  v_pk_fma_f32 v[24:25], v[114:115], v[34:35], v[24:25]
  v_pk_add_f32 v[116:117], v[116:117], v[12:13]
  v_pk_add_f32 v[118:119], v[118:119], v[12:13]
  v_cvt_pk_bf16_f32 v26, v116, v117
  v_cvt_pk_bf16_f32 v32, v118, v119
  v_lshlrev_b32 v116, 16, v26
  v_lshlrev_b32 v118, 16, v32
  v_and_b32 v117, s40, v26
  v_and_b32 v119, s40, v32
  v_pk_mul_f32 v[116:117], v[116:117], v[16:17]
  v_pk_mul_f32 v[118:119], v[118:119], v[16:17]
  v_cvt_pk_bf16_f32 v26, v116, v117
  v_cvt_pk_bf16_f32 v32, v118, v119
  v_lshlrev_b32 v116, 16, v26
  v_lshlrev_b32 v118, 16, v32
  v_and_b32 v117, s40, v26
  v_and_b32 v119, s40, v32
  v_lshlrev_b32 v28, 16, v90
  v_lshlrev_b32 v34, 16, v91
  v_and_b32 v29, s40, v90
  v_and_b32 v35, s40, v91
  v_pk_fma_f32 v[22:23], v[116:117], v[28:29], v[22:23]
  v_pk_fma_f32 v[24:25], v[118:119], v[34:35], v[24:25]
  v_pk_add_f32 v[120:121], v[120:121], v[12:13]
  v_pk_add_f32 v[122:123], v[122:123], v[12:13]
  v_cvt_pk_bf16_f32 v26, v120, v121
  v_cvt_pk_bf16_f32 v32, v122, v123
  v_lshlrev_b32 v120, 16, v26
  v_lshlrev_b32 v122, 16, v32
  v_and_b32 v121, s40, v26
  v_and_b32 v123, s40, v32
  v_pk_mul_f32 v[120:121], v[120:121], v[16:17]
  v_pk_mul_f32 v[122:123], v[122:123], v[16:17]
  v_cvt_pk_bf16_f32 v26, v120, v121
  v_cvt_pk_bf16_f32 v32, v122, v123
  v_lshlrev_b32 v120, 16, v26
  v_lshlrev_b32 v122, 16, v32
  v_and_b32 v121, s40, v26
  v_and_b32 v123, s40, v32
  v_lshlrev_b32 v28, 16, v92
  v_lshlrev_b32 v34, 16, v93
  v_and_b32 v29, s40, v92
  v_and_b32 v35, s40, v93
  v_pk_fma_f32 v[22:23], v[120:121], v[28:29], v[22:23]
  v_pk_fma_f32 v[24:25], v[122:123], v[34:35], v[24:25]
  v_pk_add_f32 v[124:125], v[124:125], v[12:13]
  v_pk_add_f32 v[126:127], v[126:127], v[12:13]
  v_cvt_pk_bf16_f32 v26, v124, v125
  v_cvt_pk_bf16_f32 v32, v126, v127
  v_lshlrev_b32 v124, 16, v26
  v_lshlrev_b32 v126, 16, v32
  v_and_b32 v125, s40, v26
  v_and_b32 v127, s40, v32
  v_pk_mul_f32 v[124:125], v[124:125], v[16:17]
  v_pk_mul_f32 v[126:127], v[126:127], v[16:17]
  v_cvt_pk_bf16_f32 v26, v124, v125
  v_cvt_pk_bf16_f32 v32, v126, v127
  v_lshlrev_b32 v124, 16, v26
  v_lshlrev_b32 v126, 16, v32
  v_and_b32 v125, s40, v26
  v_and_b32 v127, s40, v32
  v_lshlrev_b32 v28, 16, v94
  v_lshlrev_b32 v34, 16, v95
  v_and_b32 v29, s40, v94
  v_and_b32 v35, s40, v95
  v_pk_fma_f32 v[22:23], v[124:125], v[28:29], v[22:23]
  v_pk_fma_f32 v[24:25], v[126:127], v[34:35], v[24:25]
  v_pk_add_f32 v[128:129], v[128:129], v[12:13]
  v_pk_add_f32 v[130:131], v[130:131], v[12:13]
  v_cvt_pk_bf16_f32 v26, v128, v129
  v_cvt_pk_bf16_f32 v32, v130, v131
  v_lshlrev_b32 v128, 16, v26
  v_lshlrev_b32 v130, 16, v32
  v_and_b32 v129, s40, v26
  v_and_b32 v131, s40, v32
  v_pk_mul_f32 v[128:129], v[128:129], v[16:17]
  v_pk_mul_f32 v[130:131], v[130:131], v[16:17]
  v_cvt_pk_bf16_f32 v26, v128, v129
  v_cvt_pk_bf16_f32 v32, v130, v131
  v_lshlrev_b32 v128, 16, v26
  v_lshlrev_b32 v130, 16, v32
  v_and_b32 v129, s40, v26
  v_and_b32 v131, s40, v32
  v_lshlrev_b32 v28, 16, v96
  v_lshlrev_b32 v34, 16, v97
  v_and_b32 v29, s40, v96
  v_and_b32 v35, s40, v97
  v_pk_fma_f32 v[22:23], v[128:129], v[28:29], v[22:23]
  v_pk_fma_f32 v[24:25], v[130:131], v[34:35], v[24:25]
  v_pk_add_f32 v[132:133], v[132:133], v[12:13]
  v_pk_add_f32 v[134:135], v[134:135], v[12:13]
  v_cvt_pk_bf16_f32 v26, v132, v133
  v_cvt_pk_bf16_f32 v32, v134, v135
  v_lshlrev_b32 v132, 16, v26
  v_lshlrev_b32 v134, 16, v32
  v_and_b32 v133, s40, v26
  v_and_b32 v135, s40, v32
  v_pk_mul_f32 v[132:133], v[132:133], v[16:17]
  v_pk_mul_f32 v[134:135], v[134:135], v[16:17]
  v_cvt_pk_bf16_f32 v26, v132, v133
  v_cvt_pk_bf16_f32 v32, v134, v135
  v_lshlrev_b32 v132, 16, v26
  v_lshlrev_b32 v134, 16, v32
  v_and_b32 v133, s40, v26
  v_and_b32 v135, s40, v32
  v_lshlrev_b32 v28, 16, v98
  v_lshlrev_b32 v34, 16, v99
  v_and_b32 v29, s40, v98
  v_and_b32 v35, s40, v99
  v_pk_fma_f32 v[22:23], v[132:133], v[28:29], v[22:23]
  v_pk_fma_f32 v[24:25], v[134:135], v[34:35], v[24:25]
  v_pk_add_f32 v[136:137], v[136:137], v[12:13]
  v_pk_add_f32 v[138:139], v[138:139], v[12:13]
  v_cvt_pk_bf16_f32 v26, v136, v137
  v_cvt_pk_bf16_f32 v32, v138, v139
  v_lshlrev_b32 v136, 16, v26
  v_lshlrev_b32 v138, 16, v32
  v_and_b32 v137, s40, v26
  v_and_b32 v139, s40, v32
  v_pk_mul_f32 v[136:137], v[136:137], v[16:17]
  v_pk_mul_f32 v[138:139], v[138:139], v[16:17]
  v_cvt_pk_bf16_f32 v26, v136, v137
  v_cvt_pk_bf16_f32 v32, v138, v139
  v_lshlrev_b32 v136, 16, v26
  v_lshlrev_b32 v138, 16, v32
  v_and_b32 v137, s40, v26
  v_and_b32 v139, s40, v32
  v_lshlrev_b32 v28, 16, v100
  v_lshlrev_b32 v34, 16, v101
  v_and_b32 v29, s40, v100
  v_and_b32 v35, s40, v101
  v_pk_fma_f32 v[22:23], v[136:137], v[28:29], v[22:23]
  v_pk_fma_f32 v[24:25], v[138:139], v[34:35], v[24:25]
  v_pk_add_f32 v[22:23], v[22:23], v[24:25]
  s_nop 0
  v_add_f32 v22, v22, v23
  s_nop 1
  v_add_f32_dpp v22, v22, v22 quad_perm:[1,0,3,2] row_mask:0xf bank_mask:0xf
  s_nop 1
  v_add_f32_dpp v22, v22, v22 quad_perm:[2,3,0,1] row_mask:0xf bank_mask:0xf
  s_nop 1
  v_add_f32_dpp v22, v22, v22 row_half_mirror row_mask:0xf bank_mask:0xf
  s_nop 1
  v_add_f32_dpp v22, v22, v22 row_mirror row_mask:0xf bank_mask:0xf
  s_nop 0
  v_cvt_pk_bf16_f32 v23, v22, v22
  v_lshlrev_b32 v23, 16, v23
  v_ashrrev_i32 v24, 31, v23
  v_or_b32 v24, 0x80000000, v24
  v_xor_b32 v23, v23, v24
  v_and_b32 v23, s40, v23
  v_sub_u32 v24, 2047, v30
  v_or_b32 v26, v23, v24
  v_mov_b32 v27, s46
  v_cvt_pk_bf16_f32 v32, v8, v14
  v_mov_b32 v33, s46
  v_lshlrev_b32 v28, 3, v30
  s_movk_i32 s61, 8192
  s_mov_b32 s62, 32768
  v_cmp_eq_u32 vcc, 0, v2
  s_and_saveexec_b64 s[64:65], vcc
  buffer_store_dwordx2 v[26:27], v28, s[36:39], s61 offen sc1
  buffer_store_dwordx2 v[32:33], v28, s[36:39], s62 offen sc1
  s_mov_b64 exec, s[64:65]
  s_setprio 1
  s_mov_b32 s16, s72
  s_and_b32 s17, s73, 0xffff
  s_mov_b32 s18, 0x240000
  s_mov_b32 s19, 0x00020000
  v_and_b32 v1, 63, v0
  v_and_b32 v4, 255, v0
  v_mov_b32 v8, 162368
  v_mov_b32 v9, 1
  v_lshlrev_b32 v15, 2, v1
  v_lshlrev_b32 v16, 4, v1
  s_and_b32 s43, s42, 3
  s_lshl_b32 s43, s43, 12
  v_add_u32 v16, s43, v16
  s_sleep 70
  s_mov_b32 s52, 0
L_keyp_75:
  s_movk_i32 s43, 8192
  buffer_load_dwordx4 v[40:43], v16, s[36:39], s43 offen offset:0 sc1
  buffer_load_dwordx4 v[44:47], v16, s[36:39], s43 offen offset:1024 sc1
  buffer_load_dwordx4 v[48:51], v16, s[36:39], s43 offen offset:2048 sc1
  buffer_load_dwordx4 v[52:55], v16, s[36:39], s43 offen offset:3072 sc1
  s_waitcnt vmcnt(0)
  v_cmp_eq_u32 vcc, s46, v41
  v_cmp_eq_u32 s[54:55], s46, v43
  s_and_b64 vcc, vcc, s[54:55]
  v_cmp_eq_u32 s[54:55], s46, v45
  s_and_b64 vcc, vcc, s[54:55]
  v_cmp_eq_u32 s[54:55], s46, v47
  s_and_b64 vcc, vcc, s[54:55]
  v_cmp_eq_u32 s[54:55], s46, v49
  s_and_b64 vcc, vcc, s[54:55]
  v_cmp_eq_u32 s[54:55], s46, v51
  s_and_b64 vcc, vcc, s[54:55]
  v_cmp_eq_u32 s[54:55], s46, v53
  s_and_b64 vcc, vcc, s[54:55]
  v_cmp_eq_u32 s[54:55], s46, v55
  s_and_b64 vcc, vcc, s[54:55]
  s_andn2_b64 exec, exec, vcc
  s_cbranch_scc0 L_keyok_76
  s_add_u32 s52, s52, 1
  s_cmp_gt_u32 s52, 200000
  s_cbranch_scc1 L_keyok_76
  s_sleep 8
  s_branch L_keyp_75
L_keyok_76:
  s_mov_b64 exec, -1
  s_setprio 3
  v_max_u32 v41, v40, v42
  v_min_u32 v42, v40, v42
  v_max_u32 v40, v44, v46
  v_min_u32 v46, v44, v46
  v_max_u32 v44, v48, v50
  v_min_u32 v50, v48, v50
  v_max_u32 v48, v52, v54
  v_min_u32 v54, v52, v54
  v_max_u32 v52, v41, v40
  v_min_u32 v40, v41, v40
  v_max_u32 v41, v42, v46
  v_min_u32 v46, v42, v46
  v_max_u32 v42, v44, v48
  v_min_u32 v48, v44, v48
  v_max_u32 v44, v50, v54
  v_min_u32 v54, v50, v54
  v_max_u32 v50, v41, v40
  v_min_u32 v40, v41, v40
  v_max_u32 v41, v44, v48
  v_min_u32 v48, v44, v48
  v_max_u32 v44, v52, v42
  v_min_u32 v42, v52, v42
  v_max_u32 v52, v46, v54
  v_min_u32 v54, v46, v54
  v_max_u32 v46, v50, v41
  v_min_u32 v41, v50, v41
  v_max_u32 v50, v40, v48
  v_min_u32 v48, v40, v48
  v_max_u32 v40, v46, v42
  v_min_u32 v42, v46, v42
  v_max_u32 v46, v52, v48
  v_min_u32 v48, v52, v48
  v_max_u32 v52, v50, v42
  v_min_u32 v42, v50, v42
  v_max_u32 v50, v46, v41
  v_min_u32 v41, v46, v41
  v_max_u32 v46, v50, v42
  v_min_u32 v42, v50, v42
  s_nop 0
  v_max_u32_dpp v56, v44, v54 quad_perm:[1,0,3,2] row_mask:0xf bank_mask:0xf
  v_max_u32_dpp v55, v40, v48 quad_perm:[1,0,3,2] row_mask:0xf bank_mask:0xf
  v_max_u32_dpp v53, v52, v41 quad_perm:[1,0,3,2] row_mask:0xf bank_mask:0xf
  v_max_u32_dpp v51, v46, v42 quad_perm:[1,0,3,2] row_mask:0xf bank_mask:0xf
  v_max_u32_dpp v49, v42, v46 quad_perm:[1,0,3,2] row_mask:0xf bank_mask:0xf
  v_max_u32_dpp v47, v41, v52 quad_perm:[1,0,3,2] row_mask:0xf bank_mask:0xf
  v_max_u32_dpp v45, v48, v40 quad_perm:[1,0,3,2] row_mask:0xf bank_mask:0xf
  v_max_u32_dpp v43, v54, v44 quad_perm:[1,0,3,2] row_mask:0xf bank_mask:0xf
  v_max_u32 v50, v43, v51
  v_min_u32 v51, v43, v51
  v_max_u32 v43, v45, v53
  v_min_u32 v53, v45, v53
  v_max_u32 v45, v47, v55
  v_min_u32 v55, v47, v55
  v_max_u32 v47, v49, v56
  v_min_u32 v56, v49, v56
  v_max_u32 v49, v50, v45
  v_min_u32 v45, v50, v45
  v_max_u32 v50, v43, v47
  v_min_u32 v47, v43, v47
  v_max_u32 v43, v51, v55
  v_min_u32 v55, v51, v55
  v_max_u32 v51, v53, v56
  v_min_u32 v56, v53, v56
  v_max_u32 v53, v49, v50
  v_min_u32 v50, v49, v50
  v_max_u32 v49, v45, v47
  v_min_u32 v47, v45, v47
  v_max_u32 v45, v43, v51
  v_min_u32 v51, v43, v51
  v_max_u32 v43, v55, v56
  v_min_u32 v56, v55, v56
  s_nop 0
  v_max_u32_dpp v55, v53, v56 quad_perm:[2,3,0,1] row_mask:0xf bank_mask:0xf
  v_max_u32_dpp v54, v50, v43 quad_perm:[2,3,0,1] row_mask:0xf bank_mask:0xf
  v_max_u32_dpp v48, v49, v51 quad_perm:[2,3,0,1] row_mask:0xf bank_mask:0xf
  v_max_u32_dpp v41, v47, v45 quad_perm:[2,3,0,1] row_mask:0xf bank_mask:0xf
  v_max_u32_dpp v42, v45, v47 quad_perm:[2,3,0,1] row_mask:0xf bank_mask:0xf
  v_max_u32_dpp v46, v51, v49 quad_perm:[2,3,0,1] row_mask:0xf bank_mask:0xf
  v_max_u32_dpp v52, v43, v50 quad_perm:[2,3,0,1] row_mask:0xf bank_mask:0xf
  v_max_u32_dpp v40, v56, v53 quad_perm:[2,3,0,1] row_mask:0xf bank_mask:0xf
  v_max_u32 v44, v40, v41
  v_min_u32 v41, v40, v41
  v_max_u32 v40, v52, v48
  v_min_u32 v48, v52, v48
  v_max_u32 v52, v46, v54
  v_min_u32 v54, v46, v54
  v_max_u32 v46, v42, v55
  v_min_u32 v55, v42, v55
  v_max_u32 v42, v44, v52
  v_min_u32 v52, v44, v52
  v_max_u32 v44, v40, v46
  v_min_u32 v46, v40, v46
  v_max_u32 v40, v41, v54
  v_min_u32 v54, v41, v54
  v_max_u32 v41, v48, v55
  v_min_u32 v55, v48, v55
  v_max_u32 v48, v42, v44
  v_min_u32 v44, v42, v44
  v_max_u32 v42, v52, v46
  v_min_u32 v46, v52, v46
  v_max_u32 v52, v40, v41
  v_min_u32 v41, v40, v41
  v_max_u32 v40, v54, v55
  v_min_u32 v55, v54, v55
  s_nop 0
  v_max_u32_dpp v54, v48, v55 row_half_mirror row_mask:0xf bank_mask:0xf
  v_max_u32_dpp v56, v44, v40 row_half_mirror row_mask:0xf bank_mask:0xf
  v_max_u32_dpp v43, v42, v41 row_half_mirror row_mask:0xf bank_mask:0xf
  v_max_u32_dpp v51, v46, v52 row_half_mirror row_mask:0xf bank_mask:0xf
  v_max_u32_dpp v45, v52, v46 row_half_mirror row_mask:0xf bank_mask:0xf
  v_max_u32_dpp v47, v41, v42 row_half_mirror row_mask:0xf bank_mask:0xf
  v_max_u32_dpp v49, v40, v44 row_half_mirror row_mask:0xf bank_mask:0xf
  v_max_u32_dpp v50, v55, v48 row_half_mirror row_mask:0xf bank_mask:0xf
  v_max_u32 v53, v50, v51
  v_min_u32 v51, v50, v51
  v_max_u32 v50, v49, v43
  v_min_u32 v43, v49, v43
  v_max_u32 v49, v47, v56
  v_min_u32 v56, v47, v56
  v_max_u32 v47, v45, v54
  v_min_u32 v54, v45, v54
  v_max_u32 v45, v53, v49
  v_min_u32 v49, v53, v49
  v_max_u32 v53, v50, v47
  v_min_u32 v47, v50, v47
  v_max_u32 v50, v51, v56
  v_min_u32 v56, v51, v56
  v_max_u32 v51, v43, v54
  v_min_u32 v54, v43, v54
  v_max_u32 v43, v45, v53
  v_min_u32 v53, v45, v53
  v_max_u32 v45, v49, v47
  v_min_u32 v47, v49, v47
  v_max_u32 v49, v50, v51
  v_min_u32 v51, v50, v51
  v_max_u32 v50, v56, v54
  v_min_u32 v54, v56, v54
  s_nop 0
  v_max_u32_dpp v56, v43, v54 row_mirror row_mask:0xf bank_mask:0xf
  v_max_u32_dpp v55, v53, v50 row_mirror row_mask:0xf bank_mask:0xf
  v_max_u32_dpp v40, v45, v51 row_mirror row_mask:0xf bank_mask:0xf
  v_max_u32_dpp v41, v47, v49 row_mirror row_mask:0xf bank_mask:0xf
  v_max_u32_dpp v52, v49, v47 row_mirror row_mask:0xf bank_mask:0xf
  v_max_u32_dpp v46, v51, v45 row_mirror row_mask:0xf bank_mask:0xf
  v_max_u32_dpp v42, v50, v53 row_mirror row_mask:0xf bank_mask:0xf
  v_max_u32_dpp v44, v54, v43 row_mirror row_mask:0xf bank_mask:0xf
  v_max_u32 v48, v44, v41
  v_min_u32 v41, v44, v41
  v_max_u32 v44, v42, v40
  v_min_u32 v40, v42, v40
  v_max_u32 v42, v46, v55
  v_min_u32 v55, v46, v55
  v_max_u32 v46, v52, v56
  v_min_u32 v56, v52, v56
  v_max_u32 v52, v48, v42
  v_min_u32 v42, v48, v42
  v_max_u32 v48, v44, v46
  v_min_u32 v46, v44, v46
  v_max_u32 v44, v41, v55
  v_min_u32 v55, v41, v55
  v_max_u32 v41, v40, v56
  v_min_u32 v56, v40, v56
  v_max_u32 v40, v52, v48
  v_min_u32 v48, v52, v48
  v_max_u32 v52, v42, v46
  v_min_u32 v46, v42, v46
  v_max_u32 v42, v44, v41
  v_min_u32 v41, v44, v41
  v_max_u32 v44, v55, v56
  v_min_u32 v56, v55, v56
  s_nop 0
  v_max_u32_dpp v55, v40, v56 row_bcast:15 row_mask:0xa bank_mask:0xf
  v_max_u32_dpp v54, v48, v44 row_bcast:15 row_mask:0xa bank_mask:0xf
  v_max_u32_dpp v50, v52, v41 row_bcast:15 row_mask:0xa bank_mask:0xf
  v_max_u32_dpp v51, v46, v42 row_bcast:15 row_mask:0xa bank_mask:0xf
  v_max_u32_dpp v49, v42, v46 row_bcast:15 row_mask:0xa bank_mask:0xf
  v_max_u32_dpp v47, v41, v52 row_bcast:15 row_mask:0xa bank_mask:0xf
  v_max_u32_dpp v45, v44, v48 row_bcast:15 row_mask:0xa bank_mask:0xf
  v_max_u32_dpp v53, v56, v40 row_bcast:15 row_mask:0xa bank_mask:0xf
  v_max_u32 v43, v53, v51
  v_min_u32 v51, v53, v51
  v_max_u32 v53, v45, v50
  v_min_u32 v50, v45, v50
  v_max_u32 v45, v47, v54
  v_min_u32 v54, v47, v54
  v_max_u32 v47, v49, v55
  v_min_u32 v55, v49, v55
  v_max_u32 v49, v43, v45
  v_min_u32 v45, v43, v45
  v_max_u32 v43, v53, v47
  v_min_u32 v47, v53, v47
  v_max_u32 v53, v51, v54
  v_min_u32 v54, v51, v54
  v_max_u32 v51, v50, v55
  v_min_u32 v55, v50, v55
  v_max_u32 v50, v49, v43
  v_min_u32 v43, v49, v43
  v_max_u32 v49, v45, v47
  v_min_u32 v47, v45, v47
  v_max_u32 v45, v53, v51
  v_min_u32 v51, v53, v51
  v_max_u32 v53, v54, v55
  v_min_u32 v55, v54, v55
  s_nop 0
  v_max_u32_dpp v54, v50, v55 row_bcast:31 row_mask:0xc bank_mask:0xf
  v_max_u32_dpp v56, v43, v53 row_bcast:31 row_mask:0xc bank_mask:0xf
  v_max_u32_dpp v44, v49, v51 row_bcast:31 row_mask:0xc bank_mask:0xf
  v_max_u32_dpp v41, v47, v45 row_bcast:31 row_mask:0xc bank_mask:0xf
  v_max_u32_dpp v42, v45, v47 row_bcast:31 row_mask:0xc bank_mask:0xf
  v_max_u32_dpp v46, v51, v49 row_bcast:31 row_mask:0xc bank_mask:0xf
  v_max_u32_dpp v52, v53, v43 row_bcast:31 row_mask:0xc bank_mask:0xf
  v_max_u32_dpp v48, v55, v50 row_bcast:31 row_mask:0xc bank_mask:0xf
  v_max_u32 v40, v48, v41
  v_min_u32 v41, v48, v41
  v_max_u32 v48, v52, v44
  v_min_u32 v44, v52, v44
  v_max_u32 v52, v46, v56
  v_min_u32 v56, v46, v56
  v_max_u32 v46, v42, v54
  v_min_u32 v54, v42, v54
  v_max_u32 v42, v40, v52
  v_min_u32 v52, v40, v52
  v_max_u32 v40, v48, v46
  v_min_u32 v46, v48, v46
  v_max_u32 v48, v41, v56
  v_min_u32 v56, v41, v56
  v_max_u32 v41, v44, v54
  v_min_u32 v54, v44, v54
  v_max_u32 v44, v42, v40
  v_min_u32 v40, v42, v40
  v_max_u32 v42, v52, v46
  v_min_u32 v46, v52, v46
  v_max_u32 v52, v48, v41
  v_min_u32 v41, v48, v41
  v_max_u32 v48, v56, v54
  v_min_u32 v54, v56, v54
  v_mov_b32 v64, v44
  v_mov_b32 v65, v40
  v_mov_b32 v66, v42
  v_mov_b32 v67, v46
  v_mov_b32 v68, v52
  v_mov_b32 v69, v41
  v_mov_b32 v70, v48
  v_mov_b32 v71, v54
  s_and_b32 s43, s42, 3
  s_lshl_b32 s43, s43, 5
  s_add_u32 s43, s43, 162048
  v_mov_b32 v16, s43
  v_mov_b32 v31, s46
  v_mov_b32 v17, 162304
  s_mov_b32 exec_lo, 0
  s_mov_b32 exec_hi, 0x80000000
  ds_write_b128 v16, v[64:67]
  ds_write_b128 v16, v[68:71] offset:16
  ds_write_b32 v17, v31
  s_mov_b64 exec, -1
  s_waitcnt lgkmcnt(0)
  s_mov_b64 exec, 1
  ds_add_u32 v8, v9 offset:12
  s_mov_b64 exec, -1
  s_mov_b32 s52, 0
L_lw_77:
  ds_read_b32 v11, v8 offset:12
  s_add_u32 s52, s52, 1
  s_waitcnt lgkmcnt(0)
  s_cmp_gt_u32 s52, 1600000
  v_readfirstlane_b32 s51, v11
  s_cbranch_scc1 L_lwd_78
  s_nop 1
  s_cmp_ge_u32 s51, 4
  s_cbranch_scc1 L_lwd_78
  s_branch L_lw_77
L_lwd_78:
  v_mov_b32 v16, 162048
  ds_read_b128 v[64:67], v16 offset:0
  ds_read_b128 v[68:71], v16 offset:16
  ds_read_b128 v[72:75], v16 offset:32
  ds_read_b128 v[76:79], v16 offset:48
  ds_read_b128 v[80:83], v16 offset:64
  ds_read_b128 v[84:87], v16 offset:80
  ds_read_b128 v[88:91], v16 offset:96
  ds_read_b128 v[92:95], v16 offset:112
  s_waitcnt lgkmcnt(4)
  v_max_u32 v47, v71, v72
  v_max_u32 v46, v70, v73
  v_max_u32 v45, v69, v74
  v_max_u32 v44, v68, v75
  v_max_u32 v43, v67, v76
  v_max_u32 v42, v66, v77
  v_max_u32 v41, v65, v78
  v_max_u32 v40, v64, v79
  v_max_u32 v56, v40, v44
  v_min_u32 v44, v40, v44
  v_max_u32 v40, v41, v45
  v_min_u32 v45, v41, v45
  v_max_u32 v41, v42, v46
  v_min_u32 v46, v42, v46
  v_max_u32 v42, v43, v47
  v_min_u32 v47, v43, v47
  v_max_u32 v43, v56, v41
  v_min_u32 v41, v56, v41
  v_max_u32 v56, v40, v42
  v_min_u32 v42, v40, v42
  v_max_u32 v40, v44, v46
  v_min_u32 v46, v44, v46
  v_max_u32 v44, v45, v47
  v_min_u32 v47, v45, v47
  v_max_u32 v45, v43, v56
  v_min_u32 v56, v43, v56
  v_max_u32 v43, v41, v42
  v_min_u32 v42, v41, v42
  v_max_u32 v41, v40, v44
  v_min_u32 v44, v40, v44
  v_max_u32 v40, v46, v47
  v_min_u32 v47, v46, v47
  s_waitcnt lgkmcnt(0)
  v_max_u32 v55, v87, v88
  v_max_u32 v54, v86, v89
  v_max_u32 v53, v85, v90
  v_max_u32 v52, v84, v91
  v_max_u32 v51, v83, v92
  v_max_u32 v50, v82, v93
  v_max_u32 v49, v81, v94
  v_max_u32 v48, v80, v95
  v_max_u32 v57, v48, v52
  v_min_u32 v52, v48, v52
  v_max_u32 v48, v49, v53
  v_min_u32 v53, v49, v53
  v_max_u32 v49, v50, v54
  v_min_u32 v54, v50, v54
  v_max_u32 v50, v51, v55
  v_min_u32 v55, v51, v55
  v_max_u32 v51, v57, v49
  v_min_u32 v49, v57, v49
  v_max_u32 v57, v48, v50
  v_min_u32 v50, v48, v50
  v_max_u32 v48, v52, v54
  v_min_u32 v54, v52, v54
  v_max_u32 v52, v53, v55
  v_min_u32 v55, v53, v55
  v_max_u32 v53, v51, v57
  v_min_u32 v57, v51, v57
  v_max_u32 v51, v49, v50
  v_min_u32 v50, v49, v50
  v_max_u32 v49, v48, v52
  v_min_u32 v52, v48, v52
  v_max_u32 v48, v54, v55
  v_min_u32 v55, v54, v55
  v_max_u32 v64, v45, v55
  v_max_u32 v65, v56, v48
  v_max_u32 v66, v43, v52
  v_max_u32 v67, v42, v49
  v_max_u32 v68, v41, v50
  v_max_u32 v69, v44, v51
  v_max_u32 v70, v40, v57
  v_max_u32 v71, v47, v53
  v_readfirstlane_b32 s60, v64
  v_readfirstlane_b32 s61, v65
  v_readfirstlane_b32 s62, v66
  v_readfirstlane_b32 s63, v67
  v_readfirstlane_b32 s64, v68
  v_readfirstlane_b32 s65, v69
  v_readfirstlane_b32 s66, v70
  v_readfirstlane_b32 s67, v71
  s_nop 2
  s_and_b32 s45, s42, 3
  s_mov_b32 s43, s60
  s_mov_b32 s44, s61
  s_cmp_eq_u32 s45, 1
  s_cselect_b32 s43, s62, s43
  s_cselect_b32 s44, s63, s44
  s_cmp_eq_u32 s45, 2
  s_cselect_b32 s43, s64, s43
  s_cselect_b32 s44, s65, s44
  s_cmp_eq_u32 s45, 3
  s_cselect_b32 s43, s66, s43
  s_cselect_b32 s44, s67, s44
  v_mov_b32 v16, s43
  v_mov_b32 v17, s44
  v_cmp_lt_u32 vcc, 31, v1
  s_nop 1
  v_cndmask_b32 v16, v16, v17, vcc
  v_and_b32 v16, 0xffff, v16
  v_sub_u32 v16, 2047, v16
  v_and_b32 v17, 31, v1
  s_movk_i32 s43, 1152
  v_mul_lo_u32 v18, v16, s43
  v_lshl_add_u32 v18, v17, 2, v18
  v_lshlrev_b32 v19, 3, v16
  buffer_load_dword v20, v18, s[16:19], 0 offen offset:0
  buffer_load_dword v21, v18, s[16:19], 0 offen offset:128
  buffer_load_dword v22, v18, s[16:19], 0 offen offset:256
  buffer_load_dword v23, v18, s[16:19], 0 offen offset:384
  buffer_load_dword v24, v18, s[16:19], 0 offen offset:512
  buffer_load_dword v25, v18, s[16:19], 0 offen offset:640
  buffer_load_dword v26, v18, s[16:19], 0 offen offset:768
  buffer_load_dword v27, v18, s[16:19], 0 offen offset:896
  buffer_load_dword v28, v18, s[16:19], 0 offen offset:1024
  s_cmp_lg_u32 s41, 0
  s_cbranch_scc1 L_nosel_79
  s_cmp_lg_u32 s42, 4
  s_cbranch_scc1 L_nosel_79
  v_writelane_b32 v30, s60, 0
  v_writelane_b32 v30, s61, 1
  v_writelane_b32 v30, s62, 2
  v_writelane_b32 v30, s63, 3
  v_writelane_b32 v30, s64, 4
  v_writelane_b32 v30, s65, 5
  v_writelane_b32 v30, s66, 6
  v_writelane_b32 v30, s67, 7
  v_lshlrev_b32 v36, 3, v1
  s_movk_i32 s43, 256
  s_mov_b64 exec, 0xff
  buffer_store_dwordx2 v[30:31], v36, s[36:39], s43 offen sc1
  s_mov_b64 exec, -1
L_nosel_79:
  s_mov_b32 s52, 0
L_rgp_80:
  s_mov_b32 s43, 32768
  buffer_load_dwordx2 v[32:33], v19, s[36:39], s43 offen sc1
  s_waitcnt vmcnt(0)
  v_cmp_eq_u32 vcc, s46, v33
  s_andn2_b64 exec, exec, vcc
  s_cbranch_scc0 L_rgok_81
  s_add_u32 s52, s52, 1
  s_cmp_gt_u32 s52, 200000
  s_cbranch_scc1 L_rgok_81
  s_sleep 2
  s_branch L_rgp_80
L_rgok_81:
  s_mov_b64 exec, -1
  v_and_b32 v64, s40, v32
  v_lshlrev_b32 v66, 16, v32
  v_rcp_f32 v64, v64
  v_lshrrev_b32 v38, 5, v4
  v_mul_u32_u24 v38, 1168, v38
  v_mul_f32_e64 v66, -v66, v64
  v_mov_b32 v65, v64
  v_lshl_add_u32 v38, v17, 2, v38
  v_mov_b32 v67, v66
  v_add_u32 v38, 147456, v38
  v_lshlrev_b32 v40, 16, v20
  v_and_b32 v41, s40, v20
  v_lshlrev_b32 v42, 16, v21
  v_and_b32 v43, s40, v21
  v_lshlrev_b32 v44, 16, v22
  v_and_b32 v45, s40, v22
  v_lshlrev_b32 v46, 16, v23
  v_and_b32 v47, s40, v23
  v_lshlrev_b32 v48, 16, v24
  v_and_b32 v49, s40, v24
  v_lshlrev_b32 v50, 16, v25
  v_and_b32 v51, s40, v25
  v_lshlrev_b32 v52, 16, v26
  v_and_b32 v53, s40, v26
  v_lshlrev_b32 v54, 16, v27
  v_and_b32 v55, s40, v27
  v_lshlrev_b32 v56, 16, v28
  v_and_b32 v57, s40, v28
  v_pk_fma_f32 v[40:41], v[40:41], v[64:65], v[66:67]
  v_pk_fma_f32 v[42:43], v[42:43], v[64:65], v[66:67]
  v_pk_fma_f32 v[44:45], v[44:45], v[64:65], v[66:67]
  v_pk_fma_f32 v[46:47], v[46:47], v[64:65], v[66:67]
  v_pk_fma_f32 v[48:49], v[48:49], v[64:65], v[66:67]
  v_pk_fma_f32 v[50:51], v[50:51], v[64:65], v[66:67]
  v_pk_fma_f32 v[52:53], v[52:53], v[64:65], v[66:67]
  v_pk_fma_f32 v[54:55], v[54:55], v[64:65], v[66:67]
  v_pk_fma_f32 v[56:57], v[56:57], v[64:65], v[66:67]
  v_cvt_pk_bf16_f32 v70, v40, v41
  v_cvt_pk_bf16_f32 v71, v42, v43
  v_cvt_pk_bf16_f32 v72, v44, v45
  v_cvt_pk_bf16_f32 v73, v46, v47
  v_cvt_pk_bf16_f32 v74, v48, v49
  v_cvt_pk_bf16_f32 v75, v50, v51
  v_cvt_pk_bf16_f32 v76, v52, v53
  v_cvt_pk_bf16_f32 v77, v54, v55
  v_cvt_pk_bf16_f32 v78, v56, v57
  ds_write_b32 v38, v70 offset:0
  ds_write_b32 v38, v71 offset:128
  ds_write_b32 v38, v72 offset:256
  ds_write_b32 v38, v73 offset:384
  ds_write_b32 v38, v74 offset:512
  ds_write_b32 v38, v75 offset:640
  ds_write_b32 v38, v76 offset:768
  ds_write_b32 v38, v77 offset:896
  ds_write_b32 v38, v78 offset:1024
  s_waitcnt lgkmcnt(0)
  s_mov_b64 exec, 1
  ds_add_u32 v8, v9 offset:16
  s_mov_b64 exec, -1
  s_cmp_lg_u32 s41, 0
  s_cbranch_scc1 L_noep_82
  s_cmp_lg_u32 s42, 4
  s_cbranch_scc1 L_noep_82
  s_setprio 0
  v_lshlrev_b32 v16, 2, v1
  v_min_u32 v17, 15, v1
  v_lshlrev_b32 v17, 2, v17
  s_mov_b32 s52, 0
L_alp_83:
  s_movk_i32 s43, 4096
  buffer_load_dword v20, v16, s[36:39], s43 offen sc1
  buffer_load_dword v21, v16, s[36:39], s43 offen offset:256 sc1
  buffer_load_dword v22, v17, s[36:39], s43 offen offset:512 sc1
  s_waitcnt vmcnt(0)
  v_cmp_eq_u32 vcc, s46, v20
  v_cmp_eq_u32 s[54:55], s46, v21
  s_and_b64 vcc, vcc, s[54:55]
  v_cmp_eq_u32 s[54:55], s46, v22
  s_and_b64 vcc, vcc, s[54:55]
  s_andn2_b64 exec, exec, vcc
  s_cbranch_scc0 L_alok_84
  s_add_u32 s52, s52, 1
  s_cmp_gt_u32 s52, 200000
  s_cbranch_scc1 L_alok_84
  s_sleep 16
  s_branch L_alp_83
L_alok_84:
  s_mov_b64 exec, -1
  v_mov_b32 v20, s46
  v_mov_b32 v21, 0
  s_mov_b64 exec, 1
  buffer_store_dword v20, v21, s[36:39], 0 offen sc1
  s_mov_b64 exec, -1
L_noep_82:
  s_endpgm
L_spare_3:
  s_mul_i32 s31, s30, 5
  s_add_u32 s41, s41, s31
  s_lshl_b32 s60, s41, 3
  s_add_u32 s60, s60, s42
  s_add_u32 s60, s60, 288
  s_cmp_ge_u32 s60, 512
  s_cbranch_scc1 L_spx_85
  s_mov_b32 s48, s72
  s_and_b32 s49, s73, 0xffff
  s_mov_b32 s50, 0x240000
  s_mov_b32 s51, 0x00020000
  s_mov_b32 s56, s86
  s_and_b32 s57, s87, 0xffff
  s_mov_b32 s58, 0x480
  s_mov_b32 s59, 0x00020000
  v_and_b32 v1, 63, v0
  v_and_b32 v2, 15, v0
  v_lshrrev_b32 v3, 4, v1
  s_lshl_b32 s61, s60, 2
  v_add_u32 v30, s61, v3
  s_movk_i32 s62, 1152
  v_mul_lo_u32 v6, v30, s62
  v_lshl_add_u32 v6, v2, 3, v6
  v_lshlrev_b32 v7, 3, v2
  buffer_load_dwordx2 v[64:65], v6, s[48:51], 0 offen offset:0 nt
  buffer_load_dwordx2 v[66:67], v6, s[48:51], 0 offen offset:128 nt
  buffer_load_dwordx2 v[68:69], v6, s[48:51], 0 offen offset:256 nt
  buffer_load_dwordx2 v[70:71], v6, s[48:51], 0 offen offset:384 nt
  buffer_load_dwordx2 v[72:73], v6, s[48:51], 0 offen offset:512 nt
  buffer_load_dwordx2 v[74:75], v6, s[48:51], 0 offen offset:640 nt
  buffer_load_dwordx2 v[76:77], v6, s[48:51], 0 offen offset:768 nt
  buffer_load_dwordx2 v[78:79], v6, s[48:51], 0 offen offset:896 nt
  buffer_load_dwordx2 v[80:81], v6, s[48:51], 0 offen offset:1024 nt
  buffer_load_dwordx2 v[84:85], v7, s[56:59], 0 offen offset:0
  buffer_load_dwordx2 v[86:87], v7, s[56:59], 0 offen offset:128
  buffer_load_dwordx2 v[88:89], v7, s[56:59], 0 offen offset:256
  buffer_load_dwordx2 v[90:91], v7, s[56:59], 0 offen offset:384
  buffer_load_dwordx2 v[92:93], v7, s[56:59], 0 offen offset:512
  buffer_load_dwordx2 v[94:95], v7, s[56:59], 0 offen offset:640
  buffer_load_dwordx2 v[96:97], v7, s[56:59], 0 offen offset:768
  buffer_load_dwordx2 v[98:99], v7, s[56:59], 0 offen offset:896
  buffer_load_dwordx2 v[100:101], v7, s[56:59], 0 offen offset:1024
  s_waitcnt lgkmcnt(0)
  s_mul_i32 s46, s46, 0x9E3779B1
  s_add_u32 s46, s46, 0x7F4A7C15
  s_waitcnt vmcnt(0)
L_lnb_86:
  v_lshlrev_b32 v104, 16, v64
  v_and_b32 v105, s40, v64
  v_lshlrev_b32 v106, 16, v65
  v_and_b32 v107, s40, v65
  v_lshlrev_b32 v108, 16, v66
  v_and_b32 v109, s40, v66
  v_lshlrev_b32 v110, 16, v67
  v_and_b32 v111, s40, v67
  v_lshlrev_b32 v112, 16, v68
  v_and_b32 v113, s40, v68
  v_lshlrev_b32 v114, 16, v69
  v_and_b32 v115, s40, v69
  v_lshlrev_b32 v116, 16, v70
  v_and_b32 v117, s40, v70
  v_lshlrev_b32 v118, 16, v71
  v_and_b32 v119, s40, v71
  v_lshlrev_b32 v120, 16, v72
  v_and_b32 v121, s40, v72
  v_lshlrev_b32 v122, 16, v73
  v_and_b32 v123, s40, v73
  v_lshlrev_b32 v124, 16, v74
  v_and_b32 v125, s40, v74
  v_lshlrev_b32 v126, 16, v75
  v_and_b32 v127, s40, v75
  v_lshlrev_b32 v128, 16, v76
  v_and_b32 v129, s40, v76
  v_lshlrev_b32 v130, 16, v77
  v_and_b32 v131, s40, v77
  v_lshlrev_b32 v132, 16, v78
  v_and_b32 v133, s40, v78
  v_lshlrev_b32 v134, 16, v79
  v_and_b32 v135, s40, v79
  v_lshlrev_b32 v136, 16, v80
  v_and_b32 v137, s40, v80
  v_lshlrev_b32 v138, 16, v81
  v_and_b32 v139, s40, v81
  v_pk_add_f32 v[8:9], v[104:105], v[106:107]
  v_pk_add_f32 v[10:11], v[108:109], v[110:111]
  v_pk_add_f32 v[8:9], v[8:9], v[112:113]
  v_pk_add_f32 v[10:11], v[10:11], v[114:115]
  v_pk_add_f32 v[8:9], v[8:9], v[116:117]
  v_pk_add_f32 v[10:11], v[10:11], v[118:119]
  v_pk_add_f32 v[8:9], v[8:9], v[120:121]
  v_pk_add_f32 v[10:11], v[10:11], v[122:123]
  v_pk_add_f32 v[8:9], v[8:9], v[124:125]
  v_pk_add_f32 v[10:11], v[10:11], v[126:127]
  v_pk_add_f32 v[8:9], v[8:9], v[128:129]
  v_pk_add_f32 v[10:11], v[10:11], v[130:131]
  v_pk_add_f32 v[8:9], v[8:9], v[132:133]
  v_pk_add_f32 v[10:11], v[10:11], v[134:135]
  v_pk_add_f32 v[8:9], v[8:9], v[136:137]
  v_pk_add_f32 v[10:11], v[10:11], v[138:139]
  v_pk_add_f32 v[8:9], v[8:9], v[10:11]
  s_nop 0
  v_add_f32 v8, v8, v9
  s_nop 1
  v_add_f32_dpp v8, v8, v8 quad_perm:[1,0,3,2] row_mask:0xf bank_mask:0xf
  s_nop 1
  v_add_f32_dpp v8, v8, v8 quad_perm:[2,3,0,1] row_mask:0xf bank_mask:0xf
  s_nop 1
  v_add_f32_dpp v8, v8, v8 row_half_mirror row_mask:0xf bank_mask:0xf
  s_nop 1
  v_add_f32_dpp v8, v8, v8 row_mirror row_mask:0xf bank_mask:0xf
  v_mul_f32 v8, 0x3ae38e39, v8
  v_sub_f32 v12, 0, v8
  v_sub_f32 v13, 0, v8
  v_mov_b32 v14, 0
  v_mov_b32 v15, 0
  v_mov_b32 v16, 0
  v_mov_b32 v17, 0
  v_pk_add_f32 v[18:19], v[104:105], v[12:13]
  v_pk_add_f32 v[20:21], v[106:107], v[12:13]
  v_pk_fma_f32 v[14:15], v[18:19], v[18:19], v[14:15]
  v_pk_fma_f32 v[16:17], v[20:21], v[20:21], v[16:17]
  v_pk_add_f32 v[18:19], v[108:109], v[12:13]
  v_pk_add_f32 v[20:21], v[110:111], v[12:13]
  v_pk_fma_f32 v[14:15], v[18:19], v[18:19], v[14:15]
  v_pk_fma_f32 v[16:17], v[20:21], v[20:21], v[16:17]
  v_pk_add_f32 v[18:19], v[112:113], v[12:13]
  v_pk_add_f32 v[20:21], v[114:115], v[12:13]
  v_pk_fma_f32 v[14:15], v[18:19], v[18:19], v[14:15]
  v_pk_fma_f32 v[16:17], v[20:21], v[20:21], v[16:17]
  v_pk_add_f32 v[18:19], v[116:117], v[12:13]
  v_pk_add_f32 v[20:21], v[118:119], v[12:13]
  v_pk_fma_f32 v[14:15], v[18:19], v[18:19], v[14:15]
  v_pk_fma_f32 v[16:17], v[20:21], v[20:21], v[16:17]
  v_pk_add_f32 v[18:19], v[120:121], v[12:13]
  v_pk_add_f32 v[20:21], v[122:123], v[12:13]
  v_pk_fma_f32 v[14:15], v[18:19], v[18:19], v[14:15]
  v_pk_fma_f32 v[16:17], v[20:21], v[20:21], v[16:17]
  v_pk_add_f32 v[18:19], v[124:125], v[12:13]
  v_pk_add_f32 v[20:21], v[126:127], v[12:13]
  v_pk_fma_f32 v[14:15], v[18:19], v[18:19], v[14:15]
  v_pk_fma_f32 v[16:17], v[20:21], v[20:21], v[16:17]
  v_pk_add_f32 v[18:19], v[128:129], v[12:13]
  v_pk_add_f32 v[20:21], v[130:131], v[12:13]
  v_pk_fma_f32 v[14:15], v[18:19], v[18:19], v[14:15]
  v_pk_fma_f32 v[16:17], v[20:21], v[20:21], v[16:17]
  v_pk_add_f32 v[18:19], v[132:133], v[12:13]
  v_pk_add_f32 v[20:21], v[134:135], v[12:13]
  v_pk_fma_f32 v[14:15], v[18:19], v[18:19], v[14:15]
  v_pk_fma_f32 v[16:17], v[20:21], v[20:21], v[16:17]
  v_pk_add_f32 v[18:19], v[136:137], v[12:13]
  v_pk_add_f32 v[20:21], v[138:139], v[12:13]
  v_pk_fma_f32 v[14:15], v[18:19], v[18:19], v[14:15]
  v_pk_fma_f32 v[16:17], v[20:21], v[20:21], v[16:17]
  v_pk_add_f32 v[14:15], v[14:15], v[16:17]
  s_nop 0
  v_add_f32 v14, v14, v15
  s_nop 1
  v_add_f32_dpp v14, v14, v14 quad_perm:[1,0,3,2] row_mask:0xf bank_mask:0xf
  s_nop 1
  v_add_f32_dpp v14, v14, v14 quad_perm:[2,3,0,1] row_mask:0xf bank_mask:0xf
  s_nop 1
  v_add_f32_dpp v14, v14, v14 row_half_mirror row_mask:0xf bank_mask:0xf
  s_nop 1
  v_add_f32_dpp v14, v14, v14 row_mirror row_mask:0xf bank_mask:0xf
  v_mul_f32 v14, 0x3ae38e39, v14
  s_nop 0
  v_cvt_pk_bf16_f32 v9, v8, v14
  v_lshlrev_b32 v8, 16, v9
  v_and_b32 v14, s40, v9
  v_add_f32 v14, 0x3727c5ac, v14
  s_nop 0
  v_cvt_pk_bf16_f32 v9, v14, v14
  v_lshlrev_b32 v14, 16, v9
  v_sqrt_f32 v14, v14
  s_nop 0
  v_cvt_pk_bf16_f32 v9, v14, v14
  v_lshlrev_b32 v14, 16, v9
  v_rcp_f32 v15, v14
  s_nop 0
  v_fma_f32 v16, -v14, v15, 1.0
  v_fma_f32 v15, v16, v15, v15
  v_sub_f32 v12, 0, v8
  v_sub_f32 v13, 0, v8
  v_mov_b32 v16, v15
  v_mov_b32 v17, v15
  v_mov_b32 v22, 0
  v_mov_b32 v23, 0
  v_mov_b32 v24, 0
  v_mov_b32 v25, 0
  v_pk_add_f32 v[104:105], v[104:105], v[12:13]
  v_pk_add_f32 v[106:107], v[106:107], v[12:13]
  v_cvt_pk_bf16_f32 v26, v104, v105
  v_cvt_pk_bf16_f32 v32, v106, v107
  v_lshlrev_b32 v104, 16, v26
  v_lshlrev_b32 v106, 16, v32
  v_and_b32 v105, s40, v26
  v_and_b32 v107, s40, v32
  v_pk_mul_f32 v[104:105], v[104:105], v[16:17]
  v_pk_mul_f32 v[106:107], v[106:107], v[16:17]
  v_cvt_pk_bf16_f32 v26, v104, v105
  v_cvt_pk_bf16_f32 v32, v106, v107
  v_lshlrev_b32 v104, 16, v26
  v_lshlrev_b32 v106, 16, v32
  v_and_b32 v105, s40, v26
  v_and_b32 v107, s40, v32
  v_lshlrev_b32 v28, 16, v84
  v_lshlrev_b32 v34, 16, v85
  v_and_b32 v29, s40, v84
  v_and_b32 v35, s40, v85
  v_pk_fma_f32 v[22:23], v[104:105], v[28:29], v[22:23]
  v_pk_fma_f32 v[24:25], v[106:107], v[34:35], v[24:25]
  v_pk_add_f32 v[108:109], v[108:109], v[12:13]
  v_pk_add_f32 v[110:111], v[110:111], v[12:13]
  v_cvt_pk_bf16_f32 v26, v108, v109
  v_cvt_pk_bf16_f32 v32, v110, v111
  v_lshlrev_b32 v108, 16, v26
  v_lshlrev_b32 v110, 16, v32
  v_and_b32 v109, s40, v26
  v_and_b32 v111, s40, v32
  v_pk_mul_f32 v[108:109], v[108:109], v[16:17]
  v_pk_mul_f32 v[110:111], v[110:111], v[16:17]
  v_cvt_pk_bf16_f32 v26, v108, v109
  v_cvt_pk_bf16_f32 v32, v110, v111
  v_lshlrev_b32 v108, 16, v26
  v_lshlrev_b32 v110, 16, v32
  v_and_b32 v109, s40, v26
  v_and_b32 v111, s40, v32
  v_lshlrev_b32 v28, 16, v86
  v_lshlrev_b32 v34, 16, v87
  v_and_b32 v29, s40, v86
  v_and_b32 v35, s40, v87
  v_pk_fma_f32 v[22:23], v[108:109], v[28:29], v[22:23]
  v_pk_fma_f32 v[24:25], v[110:111], v[34:35], v[24:25]
  v_pk_add_f32 v[112:113], v[112:113], v[12:13]
  v_pk_add_f32 v[114:115], v[114:115], v[12:13]
  v_cvt_pk_bf16_f32 v26, v112, v113
  v_cvt_pk_bf16_f32 v32, v114, v115
  v_lshlrev_b32 v112, 16, v26
  v_lshlrev_b32 v114, 16, v32
  v_and_b32 v113, s40, v26
  v_and_b32 v115, s40, v32
  v_pk_mul_f32 v[112:113], v[112:113], v[16:17]
  v_pk_mul_f32 v[114:115], v[114:115], v[16:17]
  v_cvt_pk_bf16_f32 v26, v112, v113
  v_cvt_pk_bf16_f32 v32, v114, v115
  v_lshlrev_b32 v112, 16, v26
  v_lshlrev_b32 v114, 16, v32
  v_and_b32 v113, s40, v26
  v_and_b32 v115, s40, v32
  v_lshlrev_b32 v28, 16, v88
  v_lshlrev_b32 v34, 16, v89
  v_and_b32 v29, s40, v88
  v_and_b32 v35, s40, v89
  v_pk_fma_f32 v[22:23], v[112:113], v[28:29], v[22:23]
  v_pk_fma_f32 v[24:25], v[114:115], v[34:35], v[24:25]
  v_pk_add_f32 v[116:117], v[116:117], v[12:13]
  v_pk_add_f32 v[118:119], v[118:119], v[12:13]
  v_cvt_pk_bf16_f32 v26, v116, v117
  v_cvt_pk_bf16_f32 v32, v118, v119
  v_lshlrev_b32 v116, 16, v26
  v_lshlrev_b32 v118, 16, v32
  v_and_b32 v117, s40, v26
  v_and_b32 v119, s40, v32
  v_pk_mul_f32 v[116:117], v[116:117], v[16:17]
  v_pk_mul_f32 v[118:119], v[118:119], v[16:17]
  v_cvt_pk_bf16_f32 v26, v116, v117
  v_cvt_pk_bf16_f32 v32, v118, v119
  v_lshlrev_b32 v116, 16, v26
  v_lshlrev_b32 v118, 16, v32
  v_and_b32 v117, s40, v26
  v_and_b32 v119, s40, v32
  v_lshlrev_b32 v28, 16, v90
  v_lshlrev_b32 v34, 16, v91
  v_and_b32 v29, s40, v90
  v_and_b32 v35, s40, v91
  v_pk_fma_f32 v[22:23], v[116:117], v[28:29], v[22:23]
  v_pk_fma_f32 v[24:25], v[118:119], v[34:35], v[24:25]
  v_pk_add_f32 v[120:121], v[120:121], v[12:13]
  v_pk_add_f32 v[122:123], v[122:123], v[12:13]
  v_cvt_pk_bf16_f32 v26, v120, v121
  v_cvt_pk_bf16_f32 v32, v122, v123
  v_lshlrev_b32 v120, 16, v26
  v_lshlrev_b32 v122, 16, v32
  v_and_b32 v121, s40, v26
  v_and_b32 v123, s40, v32
  v_pk_mul_f32 v[120:121], v[120:121], v[16:17]
  v_pk_mul_f32 v[122:123], v[122:123], v[16:17]
  v_cvt_pk_bf16_f32 v26, v120, v121
  v_cvt_pk_bf16_f32 v32, v122, v123
  v_lshlrev_b32 v120, 16, v26
  v_lshlrev_b32 v122, 16, v32
  v_and_b32 v121, s40, v26
  v_and_b32 v123, s40, v32
  v_lshlrev_b32 v28, 16, v92
  v_lshlrev_b32 v34, 16, v93
  v_and_b32 v29, s40, v92
  v_and_b32 v35, s40, v93
  v_pk_fma_f32 v[22:23], v[120:121], v[28:29], v[22:23]
  v_pk_fma_f32 v[24:25], v[122:123], v[34:35], v[24:25]
  v_pk_add_f32 v[124:125], v[124:125], v[12:13]
  v_pk_add_f32 v[126:127], v[126:127], v[12:13]
  v_cvt_pk_bf16_f32 v26, v124, v125
  v_cvt_pk_bf16_f32 v32, v126, v127
  v_lshlrev_b32 v124, 16, v26
  v_lshlrev_b32 v126, 16, v32
  v_and_b32 v125, s40, v26
  v_and_b32 v127, s40, v32
  v_pk_mul_f32 v[124:125], v[124:125], v[16:17]
  v_pk_mul_f32 v[126:127], v[126:127], v[16:17]
  v_cvt_pk_bf16_f32 v26, v124, v125
  v_cvt_pk_bf16_f32 v32, v126, v127
  v_lshlrev_b32 v124, 16, v26
  v_lshlrev_b32 v126, 16, v32
  v_and_b32 v125, s40, v26
  v_and_b32 v127, s40, v32
  v_lshlrev_b32 v28, 16, v94
  v_lshlrev_b32 v34, 16, v95
  v_and_b32 v29, s40, v94
  v_and_b32 v35, s40, v95
  v_pk_fma_f32 v[22:23], v[124:125], v[28:29], v[22:23]
  v_pk_fma_f32 v[24:25], v[126:127], v[34:35], v[24:25]
  v_pk_add_f32 v[128:129], v[128:129], v[12:13]
  v_pk_add_f32 v[130:131], v[130:131], v[12:13]
  v_cvt_pk_bf16_f32 v26, v128, v129
  v_cvt_pk_bf16_f32 v32, v130, v131
  v_lshlrev_b32 v128, 16, v26
  v_lshlrev_b32 v130, 16, v32
  v_and_b32 v129, s40, v26
  v_and_b32 v131, s40, v32
  v_pk_mul_f32 v[128:129], v[128:129], v[16:17]
  v_pk_mul_f32 v[130:131], v[130:131], v[16:17]
  v_cvt_pk_bf16_f32 v26, v128, v129
  v_cvt_pk_bf16_f32 v32, v130, v131
  v_lshlrev_b32 v128, 16, v26
  v_lshlrev_b32 v130, 16, v32
  v_and_b32 v129, s40, v26
  v_and_b32 v131, s40, v32
  v_lshlrev_b32 v28, 16, v96
  v_lshlrev_b32 v34, 16, v97
  v_and_b32 v29, s40, v96
  v_and_b32 v35, s40, v97
  v_pk_fma_f32 v[22:23], v[128:129], v[28:29], v[22:23]
  v_pk_fma_f32 v[24:25], v[130:131], v[34:35], v[24:25]
  v_pk_add_f32 v[132:133], v[132:133], v[12:13]
  v_pk_add_f32 v[134:135], v[134:135], v[12:13]
  v_cvt_pk_bf16_f32 v26, v132, v133
  v_cvt_pk_bf16_f32 v32, v134, v135
  v_lshlrev_b32 v132, 16, v26
  v_lshlrev_b32 v134, 16, v32
  v_and_b32 v133, s40, v26
  v_and_b32 v135, s40, v32
  v_pk_mul_f32 v[132:133], v[132:133], v[16:17]
  v_pk_mul_f32 v[134:135], v[134:135], v[16:17]
  v_cvt_pk_bf16_f32 v26, v132, v133
  v_cvt_pk_bf16_f32 v32, v134, v135
  v_lshlrev_b32 v132, 16, v26
  v_lshlrev_b32 v134, 16, v32
  v_and_b32 v133, s40, v26
  v_and_b32 v135, s40, v32
  v_lshlrev_b32 v28, 16, v98
  v_lshlrev_b32 v34, 16, v99
  v_and_b32 v29, s40, v98
  v_and_b32 v35, s40, v99
  v_pk_fma_f32 v[22:23], v[132:133], v[28:29], v[22:23]
  v_pk_fma_f32 v[24:25], v[134:135], v[34:35], v[24:25]
  v_pk_add_f32 v[136:137], v[136:137], v[12:13]
  v_pk_add_f32 v[138:139], v[138:139], v[12:13]
  v_cvt_pk_bf16_f32 v26, v136, v137
  v_cvt_pk_bf16_f32 v32, v138, v139
  v_lshlrev_b32 v136, 16, v26
  v_lshlrev_b32 v138, 16, v32
  v_and_b32 v137, s40, v26
  v_and_b32 v139, s40, v32
  v_pk_mul_f32 v[136:137], v[136:137], v[16:17]
  v_pk_mul_f32 v[138:139], v[138:139], v[16:17]
  v_cvt_pk_bf16_f32 v26, v136, v137
  v_cvt_pk_bf16_f32 v32, v138, v139
  v_lshlrev_b32 v136, 16, v26
  v_lshlrev_b32 v138, 16, v32
  v_and_b32 v137, s40, v26
  v_and_b32 v139, s40, v32
  v_lshlrev_b32 v28, 16, v100
  v_lshlrev_b32 v34, 16, v101
  v_and_b32 v29, s40, v100
  v_and_b32 v35, s40, v101
  v_pk_fma_f32 v[22:23], v[136:137], v[28:29], v[22:23]
  v_pk_fma_f32 v[24:25], v[138:139], v[34:35], v[24:25]
  v_pk_add_f32 v[22:23], v[22:23], v[24:25]
  s_nop 0
  v_add_f32 v22, v22, v23
  s_nop 1
  v_add_f32_dpp v22, v22, v22 quad_perm:[1,0,3,2] row_mask:0xf bank_mask:0xf
  s_nop 1
  v_add_f32_dpp v22, v22, v22 quad_perm:[2,3,0,1] row_mask:0xf bank_mask:0xf
  s_nop 1
  v_add_f32_dpp v22, v22, v22 row_half_mirror row_mask:0xf bank_mask:0xf
  s_nop 1
  v_add_f32_dpp v22, v22, v22 row_mirror row_mask:0xf bank_mask:0xf
  s_nop 0
  v_cvt_pk_bf16_f32 v23, v22, v22
  v_lshlrev_b32 v23, 16, v23
  v_ashrrev_i32 v24, 31, v23
  v_or_b32 v24, 0x80000000, v24
  v_xor_b32 v23, v23, v24
  v_and_b32 v23, s40, v23
  v_sub_u32 v24, 2047, v30
  v_or_b32 v26, v23, v24
  v_mov_b32 v27, s46
  v_cvt_pk_bf16_f32 v32, v8, v14
  v_mov_b32 v33, s46
  v_lshlrev_b32 v28, 3, v30
  s_movk_i32 s61, 8192
  s_mov_b32 s62, 32768
  v_cmp_eq_u32 vcc, 0, v2
  s_and_saveexec_b64 s[64:65], vcc
  buffer_store_dwordx2 v[26:27], v28, s[36:39], s61 offen sc1
  buffer_store_dwordx2 v[32:33], v28, s[36:39], s62 offen sc1
  s_mov_b64 exec, s[64:65]
L_spx_85:
  s_endpgm
L_done_1:
  s_endpgm
L_code_end:
.section .rodata,"a"
.p2align 6
.amdhsa_kernel parallel_sum__ssm_conv_h3__moe_arch_mod__prompt_kernel
  .amdhsa_next_free_vgpr 256
  .amdhsa_next_free_sgpr 102
  .amdhsa_accum_offset 256
  .amdhsa_group_segment_fixed_size 0
  .amdhsa_kernarg_size 112
  .amdhsa_user_sgpr_count 2
  .amdhsa_user_sgpr_kernarg_segment_ptr 1
  .amdhsa_system_sgpr_workgroup_id_x 1
  .amdhsa_float_denorm_mode_32 3
.end_amdhsa_kernel
```
